```python
import torch

def _softmax(x, axis=-1):
    return torch.softmax(x, dim=axis)
def _gelu(x):
    return torch.nn.functional.gelu(x, approximate="tanh")
def _silu(x):
    return torch.nn.functional.silu(x)
def _sigmoid(x):
    return torch.sigmoid(x)
def _layernorm(x, axis=-1, eps=1e-5):
    m = x.mean(dim=axis, keepdim=True)
    v = x.var(dim=axis, keepdim=True, unbiased=False)
    return (x - m) / torch.sqrt(v + eps)
def _scatter_add(tgt, idx, src, axis=0):
    return tgt.clone().index_add_(axis, idx, src)
def _segment_sum(src, seg, n):
    out = torch.zeros((n,) + src.shape[1:], dtype=src.dtype)
    return out.index_add_(0, seg, src)
def _pad(x, pw):
    flat = tuple(v for pair in reversed(pw) for v in pair)
    return torch.nn.functional.pad(x, flat)

kernel_name = 'gated_mix__ssm_conv_s4d__grouped_kv_mqa__prompt'

def setup_inputs():

    _w = (lambda a: (lambda t: t.to(torch.bfloat16) if t.is_floating_point() else t)(torch.as_tensor(a)))
    def _A_setup():
        Bsz, L, D, N = 1, 2048, 576, 128
        return {
            "u": _w((lambda *s: torch.randn(*s, dtype=torch.bfloat16) * 0.05)(Bsz, L, D)),
            "log_A_real": _w((lambda *s: torch.randn(*s, dtype=torch.bfloat16) * 6.4)(D, N) * 0.5),
            "A_imag": _w((lambda *s: torch.randn(*s, dtype=torch.bfloat16) * 0.05)(D, N) * 3.14),
            "C_real": _w((lambda *s: torch.randn(*s, dtype=torch.bfloat16) * 0.05)(D, N) / N ** 0.5),
            "C_imag": _w((lambda *s: torch.randn(*s, dtype=torch.bfloat16) * 0.05)(D, N) / N ** 0.5),
            "log_dt": _w((lambda *s: torch.randn(*s, dtype=torch.bfloat16) * 0.05)(D) * 0.5 - 4.0),
            "D_skip": _w((lambda *s: torch.randn(*s, dtype=torch.bfloat16) * 0.05)(D)),
        }
    _A_in = _A_setup()

    def _B_setup():
        B, S, D, H = 1, 2048, 576, 32
        Dh = D // H
        return {
            "x": _w((lambda *s: torch.randn(*s, dtype=torch.bfloat16) * 0.05)(B, S, D)),
            "wq": _w((lambda *s: torch.randn(*s, dtype=torch.bfloat16) * 0.8)(D, H * Dh)),
            "wk": _w((lambda *s: torch.randn(*s, dtype=torch.bfloat16) * 0.8)(D, Dh)),
            "wv": _w((lambda *s: torch.randn(*s, dtype=torch.bfloat16) * 0.05)(D, Dh)),
            "wo": _w((lambda *s: torch.randn(*s, dtype=torch.bfloat16) * 0.05)(H * Dh, D)),
        }
    _B_in = _B_setup()

    return {
        "A_u": _A_in["u"],
        "A_log_A_real": _A_in["log_A_real"],
        "A_A_imag": _A_in["A_imag"],
        "A_C_real": _A_in["C_real"],
        "A_C_imag": _A_in["C_imag"],
        "A_log_dt": _A_in["log_dt"],
        "A_D_skip": _A_in["D_skip"],
        "B_x": _B_in["x"],
        "B_wq": _B_in["wq"],
        "B_wk": _B_in["wk"],
        "B_wv": _B_in["wv"],
        "B_wo": _B_in["wo"],
        "gate_w": _w((lambda *s: torch.randn(*s, dtype=torch.bfloat16) * 0.05)(576) * 16.0),
    }

def reference(A_u, A_log_A_real, A_A_imag, A_C_real, A_C_imag, A_log_dt, A_D_skip, B_x, B_wq, B_wk, B_wv, B_wo, gate_w):
    def _A_ref(u, log_A_real, A_imag, C_real, C_imag, log_dt, D_skip):
        L = u.shape[1]
        dt = torch.exp(log_dt)
        A = -torch.exp(log_A_real) + 1j * A_imag
        C = (C_real + 1j * C_imag) * dt[:, None]
        pos = (lambda x, dt: x.to(dt))(torch.arange(L), log_dt.dtype)
        P = torch.exp((A * dt[:, None])[:, :, None] * pos[None, None, :])
        K = 2.0 * torch.einsum("dn,dnl->dl", C, P).real
        L2 = 2 * L
        u_t = (lambda x, *d: x.permute(*d))(u, 0, 2, 1)
        Kf = (lambda x, *a, **k: torch.fft.rfft(x.float(), *a, **k))(K, L2)
        Uf = (lambda x, *a, **k: torch.fft.rfft(x.float(), *a, **k))(u_t, L2)
        y = (lambda x, *a, **k: torch.fft.irfft(x, *a, **k).to(torch.bfloat16))(Uf * Kf[None, :, :], L2)[:, :, :L]
        y = (lambda x, *d: x.permute(*d))(y, 0, 2, 1)
        return y + u * D_skip[None, None, :]

    def _B_ref(x, wq, wk, wv, wo):
        B, S, D = x.shape
        H = 32
        Dh = D // H
        q = (lambda x, *d: x.permute(*d))((x @ wq).reshape(B, S, H, Dh), 0, 2, 1, 3)
        k = x @ wk
        v = x @ wv
        scores = torch.einsum("bhqd,bkd->bhqk", q, k) * (Dh ** -0.5)
        p = _softmax(scores, axis=-1)
        o = torch.einsum("bhqk,bkd->bhqd", p, v)
        return (lambda x, *d: x.permute(*d))(o, 0, 2, 1, 3).reshape(B, S, H * Dh) @ wo

    x = A_u
    g = _sigmoid((x * gate_w).sum(-1, keepdims=True))
    a = _A_ref(x, A_log_A_real, A_A_imag, A_C_real, A_C_imag, A_log_dt, A_D_skip)
    b = _B_ref(x, B_wq, B_wk, B_wv, B_wo)
    return g * a + (1 - g) * b
```

```asm
; @launch kernel=k0_kernel grid=(940,1,1) block=(256,1,1) lds=36352
; @launch kernel=k1_kernel grid=(848,1,1) block=(256,1,1) lds=40960
; @launch kernel=k2_kernel grid=(256,1,1) block=(1024,1,1) lds=156672
; @launch kernel=k3_kernel grid=(144,1,1) block=(256,1,1) lds=65536
.amdgcn_target "amdgcn-amd-amdhsa--gfx950"
.text
.globl k0_kernel
.p2align 8
.type k0_kernel,@function
k0_kernel:
  s_cmp_ge_u32 s2, 940
  s_cbranch_scc1 K0_END
  s_load_dwordx16 s[16:31], s[0:1], 0
  s_load_dwordx8 s[32:39], s[0:1], 64
  s_load_dwordx2 s[40:41], s[0:1], 96
  s_load_dwordx2 s[46:47], s[0:1], 120
  v_and_b32 v2, 63, v0
  v_lshrrev_b32 v1, 6, v0
  s_nop 0
  v_readfirstlane_b32 s3, v1
  v_and_b32 v5, 31, v2
  v_lshrrev_b32 v6, 5, v2
  v_lshlrev_b32 v7, 4, v2
  s_waitcnt lgkmcnt(0)

  s_mov_b32 s48, s16
  s_and_b32 s49, s17, 0xffff
  s_mov_b32 s50, 2359296
  s_mov_b32 s51, 0x00020000
  s_mov_b32 s56, s46
  s_and_b32 s57, s47, 0xffff
  s_mov_b32 s58, 268435456
  s_mov_b32 s59, 0x00020000
  s_cmp_lt_u32 s2, 576
  s_cbranch_scc1 K0_KG
  s_sub_u32 s2, s2, 576
  s_cmp_ge_u32 s2, 144
  s_cbranch_scc1 K0_XW

  s_mul_i32 s4, s2, 7282
  s_lshr_b32 s4, s4, 16
  s_mul_i32 s6, s4, 9
  s_sub_u32 s6, s2, s6
  v_lshrrev_b32 v8, 3, v2
  v_mul_u32_u24 v8, 1152, v8
  v_and_b32 v9, 7, v2
  v_lshl_add_u32 v8, v9, 4, v8
  s_mul_i32 s7, s4, 147456
  s_lshl_b32 s8, s6, 7
  s_add_u32 s7, s7, s8
  s_mul_i32 s8, s3, 36864
  s_add_u32 s7, s7, s8
  s_lshl_b32 s9, s3, 12

  s_add_u32 m0, s9, 0
  s_add_u32 s10, s7, 0
  buffer_load_dwordx4 v8, s[48:51], s10 offen lds
  s_add_u32 m0, s9, 1024
  s_add_u32 s10, s7, 9216
  buffer_load_dwordx4 v8, s[48:51], s10 offen lds
  s_add_u32 m0, s9, 2048
  s_add_u32 s10, s7, 18432
  buffer_load_dwordx4 v8, s[48:51], s10 offen lds
  s_add_u32 m0, s9, 3072
  s_add_u32 s10, s7, 27648
  buffer_load_dwordx4 v8, s[48:51], s10 offen lds
  v_bfe_u32 v10, v2, 2, 2
  v_lshlrev_b32 v10, 7, v10
  v_lshrrev_b32 v11, 4, v2
  v_lshl_add_u32 v10, v11, 5, v10
  v_and_b32 v11, 3, v2
  v_lshl_add_u32 v10, v11, 3, v10
  v_add_u32 v10, s9, v10
  v_lshlrev_b32 v12, 12, v2
  s_lshl_b32 s10, s6, 18
  s_lshl_b32 s11, s4, 8
  s_add_u32 s10, s10, s11
  s_lshl_b32 s11, s3, 6
  s_add_u32 s10, s10, s11
  s_add_u32 s10, s10, 19922944
  s_waitcnt vmcnt(0)

  ds_read_b64_tr_b16 v[16:17], v10 offset:0
  ds_read_b64_tr_b16 v[18:19], v10 offset:512
  ds_read_b64_tr_b16 v[20:21], v10 offset:1024
  ds_read_b64_tr_b16 v[22:23], v10 offset:1536
  ds_read_b64_tr_b16 v[24:25], v10 offset:2048
  ds_read_b64_tr_b16 v[26:27], v10 offset:2560
  ds_read_b64_tr_b16 v[28:29], v10 offset:3072
  ds_read_b64_tr_b16 v[30:31], v10 offset:3584
  s_waitcnt lgkmcnt(6)
  buffer_store_dwordx4 v[16:19], v12, s[56:59], s10 offen offset:0 sc1
  s_waitcnt lgkmcnt(4)
  buffer_store_dwordx4 v[20:23], v12, s[56:59], s10 offen offset:16 sc1
  s_waitcnt lgkmcnt(2)
  buffer_store_dwordx4 v[24:27], v12, s[56:59], s10 offen offset:32 sc1
  s_waitcnt lgkmcnt(0)
  buffer_store_dwordx4 v[28:31], v12, s[56:59], s10 offen offset:48 sc1
  s_endpgm
K0_XW:
  s_sub_u32 s2, s2, 144
  s_cmp_ge_u32 s2, 64
  s_cbranch_scc1 K0_W

  s_and_b32 s4, s2, 7
  s_lshl_b32 s4, s4, 3
  s_lshr_b32 s2, s2, 3
  s_add_u32 s2, s2, s4
  s_lshl_b32 s4, s2, 5
  v_add_u32 v8, s4, v5
  s_movk_i32 s5, 1152
  v_mul_lo_u32 v8, v8, s5
  v_lshl_add_u32 v8, v6, 4, v8
  s_mul_i32 s6, s3, 288
  s_mul_i32 s7, s2, 36864
  s_mul_i32 s8, s3, 9216
  s_add_u32 s7, s7, s8
  s_add_u32 s7, s7, 16777216

  buffer_load_dwordx4 v[16:19], v8, s[48:51], s6 offen offset:0
  buffer_load_dwordx4 v[20:23], v8, s[48:51], s6 offen offset:32
  buffer_load_dwordx4 v[24:27], v8, s[48:51], s6 offen offset:64
  buffer_load_dwordx4 v[28:31], v8, s[48:51], s6 offen offset:96
  buffer_load_dwordx4 v[32:35], v8, s[48:51], s6 offen offset:128
  buffer_load_dwordx4 v[36:39], v8, s[48:51], s6 offen offset:160
  buffer_load_dwordx4 v[40:43], v8, s[48:51], s6 offen offset:192
  buffer_load_dwordx4 v[44:47], v8, s[48:51], s6 offen offset:224
  buffer_load_dwordx4 v[48:51], v8, s[48:51], s6 offen offset:256
  s_waitcnt vmcnt(8)
  s_add_u32 s9, s7, 0
  buffer_store_dwordx4 v[16:19], v7, s[56:59], s9 offen sc1
  s_waitcnt vmcnt(8)
  s_add_u32 s9, s7, 1024
  buffer_store_dwordx4 v[20:23], v7, s[56:59], s9 offen sc1
  s_waitcnt vmcnt(8)
  s_add_u32 s9, s7, 2048
  buffer_store_dwordx4 v[24:27], v7, s[56:59], s9 offen sc1
  s_waitcnt vmcnt(8)
  s_add_u32 s9, s7, 3072
  buffer_store_dwordx4 v[28:31], v7, s[56:59], s9 offen sc1
  s_waitcnt vmcnt(8)
  s_add_u32 s9, s7, 4096
  buffer_store_dwordx4 v[32:35], v7, s[56:59], s9 offen sc1
  s_waitcnt vmcnt(8)
  s_add_u32 s9, s7, 5120
  buffer_store_dwordx4 v[36:39], v7, s[56:59], s9 offen sc1
  s_waitcnt vmcnt(8)
  s_add_u32 s9, s7, 6144
  buffer_store_dwordx4 v[40:43], v7, s[56:59], s9 offen sc1
  s_waitcnt vmcnt(8)
  s_add_u32 s9, s7, 7168
  buffer_store_dwordx4 v[44:47], v7, s[56:59], s9 offen sc1
  s_waitcnt vmcnt(8)
  s_add_u32 s9, s7, 8192
  buffer_store_dwordx4 v[48:51], v7, s[56:59], s9 offen sc1
  s_endpgm
K0_W:
  s_sub_u32 s2, s2, 64
  s_mul_i32 s4, s2, 21846
  s_lshr_b32 s4, s4, 16
  s_mul_i32 s5, s4, 3
  s_sub_u32 s5, s2, s5
  s_mov_b32 s2, s4
  s_lshl_b32 s5, s5, 2
  s_add_u32 s3, s3, s5
  s_mov_b32 s60, 1152
  s_mul_i32 s61, s2, 36
  s_mov_b32 s62, 23068672
  s_mul_i32 s63, s2, 36864
  s_add_u32 s62, s62, s63
  s_mov_b32 s64, s32
  s_mov_b32 s65, s33
  s_mov_b32 s66, 663552
  s_cmp_lt_u32 s2, 32
  s_cbranch_scc1 K0_WGO
  s_mov_b32 s60, 36
  s_mov_b32 s61, 0
  s_mov_b32 s62, 25165824
  s_mov_b32 s64, s34
  s_mov_b32 s65, s35
  s_mov_b32 s66, 20736
  s_cmp_eq_u32 s2, 32
  s_cbranch_scc1 K0_WGO
  s_mov_b32 s62, 25231360
  s_mov_b32 s64, s36
  s_mov_b32 s65, s37
  s_cmp_eq_u32 s2, 33
  s_cbranch_scc1 K0_WGO
  s_sub_u32 s67, s2, 34
  s_mov_b32 s60, 1152
  s_lshl_b32 s61, s67, 6
  s_mul_i32 s63, s67, 36864
  s_add_u32 s62, s63, 26214400
  s_mov_b32 s64, s38
  s_mov_b32 s65, s39
  s_mov_b32 s66, 663552
  K0_WGO:
  s_mov_b32 s52, s64
  s_and_b32 s53, s65, 0xffff
  s_mov_b32 s54, s66
  s_mov_b32 s55, 0x00020000

  s_mov_b32 s72, s40
  s_and_b32 s73, s41, 0xffff
  s_mov_b32 s74, 1152
  s_mov_b32 s75, 0x00020000
  s_lshl_b32 s67, s60, 3
  v_mul_lo_u32 v8, v6, s67
  v_lshl_add_u32 v8, v5, 1, v8
  v_add_u32 v8, s61, v8
  s_mul_i32 s68, s3, 48
  s_mul_i32 s68, s68, s60
  s_mul_i32 s69, s3, 3072
  s_add_u32 s62, s62, s69
  s_mul_i32 s70, s3, 96
  v_lshlrev_b32 v9, 4, v6
  v_cmp_eq_u32 s[76:77], 18, v5
  s_nop 3
  s_cmp_eq_u32 s2, 32
  s_cselect_b64 s[76:77], s[76:77], 0

  buffer_load_ushort v16, v8, s[52:55], s68 offen
  s_add_u32 s68, s68, s60
  buffer_load_ushort v17, v8, s[52:55], s68 offen
  s_add_u32 s68, s68, s60
  buffer_load_ushort v18, v8, s[52:55], s68 offen
  s_add_u32 s68, s68, s60
  buffer_load_ushort v19, v8, s[52:55], s68 offen
  s_add_u32 s68, s68, s60
  buffer_load_ushort v20, v8, s[52:55], s68 offen
  s_add_u32 s68, s68, s60
  buffer_load_ushort v21, v8, s[52:55], s68 offen
  s_add_u32 s68, s68, s60
  buffer_load_ushort v22, v8, s[52:55], s68 offen
  s_add_u32 s68, s68, s60
  buffer_load_ushort v23, v8, s[52:55], s68 offen
  s_add_u32 s68, s68, s60
  buffer_load_dwordx4 v[88:91], v9, s[72:75], s70 offen offset:0
  s_add_u32 s68, s68, s67
  buffer_load_ushort v24, v8, s[52:55], s68 offen
  s_add_u32 s68, s68, s60
  buffer_load_ushort v25, v8, s[52:55], s68 offen
  s_add_u32 s68, s68, s60
  buffer_load_ushort v26, v8, s[52:55], s68 offen
  s_add_u32 s68, s68, s60
  buffer_load_ushort v27, v8, s[52:55], s68 offen
  s_add_u32 s68, s68, s60
  buffer_load_ushort v28, v8, s[52:55], s68 offen
  s_add_u32 s68, s68, s60
  buffer_load_ushort v29, v8, s[52:55], s68 offen
  s_add_u32 s68, s68, s60
  buffer_load_ushort v30, v8, s[52:55], s68 offen
  s_add_u32 s68, s68, s60
  buffer_load_ushort v31, v8, s[52:55], s68 offen
  s_add_u32 s68, s68, s60
  buffer_load_dwordx4 v[92:95], v9, s[72:75], s70 offen offset:32
  s_add_u32 s68, s68, s67
  buffer_load_ushort v32, v8, s[52:55], s68 offen
  s_add_u32 s68, s68, s60
  buffer_load_ushort v33, v8, s[52:55], s68 offen
  s_add_u32 s68, s68, s60
  buffer_load_ushort v34, v8, s[52:55], s68 offen
  s_add_u32 s68, s68, s60
  buffer_load_ushort v35, v8, s[52:55], s68 offen
  s_add_u32 s68, s68, s60
  buffer_load_ushort v36, v8, s[52:55], s68 offen
  s_add_u32 s68, s68, s60
  buffer_load_ushort v37, v8, s[52:55], s68 offen
  s_add_u32 s68, s68, s60
  buffer_load_ushort v38, v8, s[52:55], s68 offen
  s_add_u32 s68, s68, s60
  buffer_load_ushort v39, v8, s[52:55], s68 offen
  s_add_u32 s68, s68, s60
  buffer_load_dwordx4 v[96:99], v9, s[72:75], s70 offen offset:64
  s_add_u32 s68, s68, s67
  s_waitcnt vmcnt(18)
  v_lshl_or_b32 v16, v17, 16, v16
  v_lshl_or_b32 v17, v19, 16, v18
  v_lshl_or_b32 v18, v21, 16, v20
  v_lshl_or_b32 v19, v23, 16, v22
  v_cndmask_b32 v16, v16, v88, s[76:77]
  v_cndmask_b32 v17, v17, v89, s[76:77]
  v_cndmask_b32 v18, v18, v90, s[76:77]
  v_cndmask_b32 v19, v19, v91, s[76:77]
  s_add_u32 s71, s62, 0
  buffer_store_dwordx4 v[16:19], v7, s[56:59], s71 offen sc1
  s_waitcnt vmcnt(10)
  v_lshl_or_b32 v24, v25, 16, v24
  v_lshl_or_b32 v25, v27, 16, v26
  v_lshl_or_b32 v26, v29, 16, v28
  v_lshl_or_b32 v27, v31, 16, v30
  v_cndmask_b32 v24, v24, v92, s[76:77]
  v_cndmask_b32 v25, v25, v93, s[76:77]
  v_cndmask_b32 v26, v26, v94, s[76:77]
  v_cndmask_b32 v27, v27, v95, s[76:77]
  s_add_u32 s71, s62, 1024
  buffer_store_dwordx4 v[24:27], v7, s[56:59], s71 offen sc1
  s_waitcnt vmcnt(2)
  v_lshl_or_b32 v32, v33, 16, v32
  v_lshl_or_b32 v33, v35, 16, v34
  v_lshl_or_b32 v34, v37, 16, v36
  v_lshl_or_b32 v35, v39, 16, v38
  v_cndmask_b32 v32, v32, v96, s[76:77]
  v_cndmask_b32 v33, v33, v97, s[76:77]
  v_cndmask_b32 v34, v34, v98, s[76:77]
  v_cndmask_b32 v35, v35, v99, s[76:77]
  s_add_u32 s71, s62, 2048
  buffer_store_dwordx4 v[32:35], v7, s[56:59], s71 offen sc1
  K0_END:
  s_endpgm

K0_KG:
  s_mov_b32 s56, s46
  s_and_b32 s57, s47, 0xffff
  s_mov_b32 s58, 268435456
  s_mov_b32 s59, 0x00020000
  s_mov_b32 s68, s18
  s_and_b32 s69, s19, 0xffff
  s_mov_b32 s70, 147456
  s_mov_b32 s71, 0x00020000
  s_mov_b32 s72, s20
  s_and_b32 s73, s21, 0xffff
  s_mov_b32 s74, 147456
  s_mov_b32 s75, 0x00020000
  s_mov_b32 s76, s22
  s_and_b32 s77, s23, 0xffff
  s_mov_b32 s78, 147456
  s_mov_b32 s79, 0x00020000
  s_mov_b32 s80, s24
  s_and_b32 s81, s25, 0xffff
  s_mov_b32 s82, 147456
  s_mov_b32 s83, 0x00020000
  s_mov_b32 s84, s26
  s_and_b32 s85, s27, 0xffff
  s_mov_b32 s86, 1152
  s_mov_b32 s87, 0x00020000
  s_lshl_b32 s4, s2, 1
  v_lshlrev_b32 v4, 1, v2
  s_lshl_b32 s5, s2, 8
  v_mov_b32 v5, s4
  buffer_load_ushort v24, v5, s[84:87], 0 offen
  buffer_load_ushort v16, v4, s[68:71], s5 offen
  buffer_load_ushort v17, v4, s[72:75], s5 offen
  buffer_load_ushort v18, v4, s[76:79], s5 offen
  buffer_load_ushort v19, v4, s[80:83], s5 offen
  buffer_load_ushort v20, v4, s[68:71], s5 offen offset:128
  buffer_load_ushort v21, v4, s[72:75], s5 offen offset:128
  buffer_load_ushort v22, v4, s[76:79], s5 offen offset:128
  buffer_load_ushort v23, v4, s[80:83], s5 offen offset:128

  v_mov_b32 v28, 0
  v_mov_b32 v29, 0
  v_mov_b32 v30, 0
  v_mov_b32 v31, 0
  v_lshlrev_b32 v6, 4, v0
  v_cmp_gt_u32 vcc, 64, v0
  s_and_saveexec_b64 s[12:13], vcc
  v_mov_b32 v7, 36216
  ds_write_b16 v7, v28
  s_mov_b64 exec, s[12:13]
  s_mov_b32 s8, 1
  s_lshl_b32 s8, s8, s3
  v_cvt_f32_u32 v6, s8
  s_nop 0
  v_readfirstlane_b32 s88, v6
  v_mul_f32 v6, 0x41800000, v6
  s_nop 0
  v_readfirstlane_b32 s89, v6
  v_mul_f32 v6, 0x41000000, v6
  s_cmp_eq_u32 s3, 0
  s_cselect_b32 s6, 0, 8
  v_readfirstlane_b32 s90, v6
  s_nop 3
  s_cselect_b32 s90, 0, s90
  s_mul_i32 s91, s3, 8704
  v_lshlrev_b32 v8, 2, v2
  v_add_u32 v8, s91, v8
  v_and_b32 v4, 15, v2
  v_lshrrev_b32 v5, 4, v2
  v_mul_u32_u24 v9, 272, v4
  v_lshl_add_u32 v9, v5, 4, v9
  v_add_u32 v9, s91, v9
  v_mov_b32 v40, 0
  v_mov_b32 v41, 0
  v_mov_b32 v42, 0
  v_mov_b32 v43, 0
  s_waitcnt vmcnt(0)
  v_lshlrev_b32 v24, 16, v24
  v_mul_f32 v24, 0x3fb8aa3b, v24
  v_exp_f32 v24, v24
  s_nop 0
  v_cvt_pk_bf16_f32 v24, v24, v24
  v_lshlrev_b32 v24, 16, v24

  v_lshlrev_b32 v16, 16, v16
  v_lshlrev_b32 v17, 16, v17
  v_lshlrev_b32 v18, 16, v18
  v_lshlrev_b32 v19, 16, v19
  v_mul_f32 v16, 0x3fb8aa3b, v16
  v_exp_f32 v16, v16
  s_nop 0
  v_cvt_pk_bf16_f32 v16, v16, v16
  v_lshlrev_b32 v16, 16, v16
  v_mul_f32 v16, v16, v24
  v_mul_f32 v44, 0xbfb8aa3b, v16
  v_mul_f32 v17, v17, v24
  v_mul_f32 v45, 0x3e22f983, v17
  v_mul_f32 v18, v18, v24
  v_add_f32 v46, v18, v18
  v_mul_f32 v19, v19, v24
  v_add_f32 v47, v19, v19

  v_mul_f32 v60, s88, v44
  v_mul_f32 v61, s88, v45
  v_exp_f32 v60, v60
  v_fract_f32 v61, v61
  v_cos_f32 v48, v61
  v_sin_f32 v49, v61
  s_nop 0
  v_mul_f32 v48, v60, v48
  v_mul_f32 v49, v60, v49

  v_mul_f32 v60, s89, v44
  v_mul_f32 v61, s89, v45
  v_exp_f32 v60, v60
  v_fract_f32 v61, v61
  v_cos_f32 v51, v61
  v_sin_f32 v52, v61
  s_nop 0
  v_mul_f32 v51, v60, v51
  v_mul_f32 v52, v60, v52

  v_mul_f32 v60, s90, v44
  v_mul_f32 v61, s90, v45
  v_exp_f32 v60, v60
  v_fract_f32 v61, v61
  v_cos_f32 v54, v61
  v_sin_f32 v55, v61
  s_nop 0
  v_mul_f32 v54, v60, v54
  v_mul_f32 v55, v60, v55

  v_sub_f32 v50, 0, v49
  v_sub_f32 v53, 0, v52
  v_sub_f32 v58, 0, v47

  v_mul_f32 v56, v54, v46
  v_mul_f32 v57, v54, v47
  v_fmac_f32 v56, v55, v58
  v_fmac_f32 v57, v55, v46
  v_mov_b32 v72, 0x00003f80
  ds_write_b32 v8, v72 offset:4352
  v_cvt_pk_bf16_f32 v73, v56, v57
  ds_write_b32 v8, v73 offset:0
  v_mov_b32 v64, v48
  v_mov_b32 v65, v49
  v_mul_f32 v68, v56, v51
  v_mul_f32 v69, v56, v52
  v_fmac_f32 v68, v57, v53
  v_fmac_f32 v69, v57, v51
  v_cvt_pk_bf16_f32 v72, v64, -v65
  v_cvt_pk_bf16_f32 v73, v68, v69
  ds_write_b32 v8, v72 offset:4624
  ds_write_b32 v8, v73 offset:272
  v_mul_f32 v66, v64, v48
  v_mul_f32 v67, v64, v49
  v_fmac_f32 v66, v65, v50
  v_fmac_f32 v67, v65, v48
  v_mul_f32 v70, v68, v51
  v_mul_f32 v71, v68, v52
  v_fmac_f32 v70, v69, v53
  v_fmac_f32 v71, v69, v51
  v_cvt_pk_bf16_f32 v72, v66, -v67
  v_cvt_pk_bf16_f32 v73, v70, v71
  ds_write_b32 v8, v72 offset:4896
  ds_write_b32 v8, v73 offset:544
  v_mul_f32 v64, v66, v48
  v_mul_f32 v65, v66, v49
  v_fmac_f32 v64, v67, v50
  v_fmac_f32 v65, v67, v48
  v_mul_f32 v68, v70, v51
  v_mul_f32 v69, v70, v52
  v_fmac_f32 v68, v71, v53
  v_fmac_f32 v69, v71, v51
  v_cvt_pk_bf16_f32 v72, v64, -v65
  v_cvt_pk_bf16_f32 v73, v68, v69
  ds_write_b32 v8, v72 offset:5168
  ds_write_b32 v8, v73 offset:816
  v_mul_f32 v66, v64, v48
  v_mul_f32 v67, v64, v49
  v_fmac_f32 v66, v65, v50
  v_fmac_f32 v67, v65, v48
  v_mul_f32 v70, v68, v51
  v_mul_f32 v71, v68, v52
  v_fmac_f32 v70, v69, v53
  v_fmac_f32 v71, v69, v51
  v_cvt_pk_bf16_f32 v72, v66, -v67
  v_cvt_pk_bf16_f32 v73, v70, v71
  ds_write_b32 v8, v72 offset:5440
  ds_write_b32 v8, v73 offset:1088
  v_mul_f32 v64, v66, v48
  v_mul_f32 v65, v66, v49
  v_fmac_f32 v64, v67, v50
  v_fmac_f32 v65, v67, v48
  v_mul_f32 v68, v70, v51
  v_mul_f32 v69, v70, v52
  v_fmac_f32 v68, v71, v53
  v_fmac_f32 v69, v71, v51
  v_cvt_pk_bf16_f32 v72, v64, -v65
  v_cvt_pk_bf16_f32 v73, v68, v69
  ds_write_b32 v8, v72 offset:5712
  ds_write_b32 v8, v73 offset:1360
  v_mul_f32 v66, v64, v48
  v_mul_f32 v67, v64, v49
  v_fmac_f32 v66, v65, v50
  v_fmac_f32 v67, v65, v48
  v_mul_f32 v70, v68, v51
  v_mul_f32 v71, v68, v52
  v_fmac_f32 v70, v69, v53
  v_fmac_f32 v71, v69, v51
  v_cvt_pk_bf16_f32 v72, v66, -v67
  v_cvt_pk_bf16_f32 v73, v70, v71
  ds_write_b32 v8, v72 offset:5984
  ds_write_b32 v8, v73 offset:1632
  v_mul_f32 v64, v66, v48
  v_mul_f32 v65, v66, v49
  v_fmac_f32 v64, v67, v50
  v_fmac_f32 v65, v67, v48
  v_mul_f32 v68, v70, v51
  v_mul_f32 v69, v70, v52
  v_fmac_f32 v68, v71, v53
  v_fmac_f32 v69, v71, v51
  v_cvt_pk_bf16_f32 v72, v64, -v65
  v_cvt_pk_bf16_f32 v73, v68, v69
  ds_write_b32 v8, v72 offset:6256
  ds_write_b32 v8, v73 offset:1904
  v_mul_f32 v66, v64, v48
  v_mul_f32 v67, v64, v49
  v_fmac_f32 v66, v65, v50
  v_fmac_f32 v67, v65, v48
  v_mul_f32 v70, v68, v51
  v_mul_f32 v71, v68, v52
  v_fmac_f32 v70, v69, v53
  v_fmac_f32 v71, v69, v51
  v_cvt_pk_bf16_f32 v72, v66, -v67
  v_cvt_pk_bf16_f32 v73, v70, v71
  ds_write_b32 v8, v72 offset:6528
  ds_write_b32 v8, v73 offset:2176
  v_mul_f32 v64, v66, v48
  v_mul_f32 v65, v66, v49
  v_fmac_f32 v64, v67, v50
  v_fmac_f32 v65, v67, v48
  v_mul_f32 v68, v70, v51
  v_mul_f32 v69, v70, v52
  v_fmac_f32 v68, v71, v53
  v_fmac_f32 v69, v71, v51
  v_cvt_pk_bf16_f32 v72, v64, -v65
  v_cvt_pk_bf16_f32 v73, v68, v69
  ds_write_b32 v8, v72 offset:6800
  ds_write_b32 v8, v73 offset:2448
  v_mul_f32 v66, v64, v48
  v_mul_f32 v67, v64, v49
  v_fmac_f32 v66, v65, v50
  v_fmac_f32 v67, v65, v48
  v_mul_f32 v70, v68, v51
  v_mul_f32 v71, v68, v52
  v_fmac_f32 v70, v69, v53
  v_fmac_f32 v71, v69, v51
  v_cvt_pk_bf16_f32 v72, v66, -v67
  v_cvt_pk_bf16_f32 v73, v70, v71
  ds_write_b32 v8, v72 offset:7072
  ds_write_b32 v8, v73 offset:2720
  v_mul_f32 v64, v66, v48
  v_mul_f32 v65, v66, v49
  v_fmac_f32 v64, v67, v50
  v_fmac_f32 v65, v67, v48
  v_mul_f32 v68, v70, v51
  v_mul_f32 v69, v70, v52
  v_fmac_f32 v68, v71, v53
  v_fmac_f32 v69, v71, v51
  v_cvt_pk_bf16_f32 v72, v64, -v65
  v_cvt_pk_bf16_f32 v73, v68, v69
  ds_write_b32 v8, v72 offset:7344
  ds_write_b32 v8, v73 offset:2992
  v_mul_f32 v66, v64, v48
  v_mul_f32 v67, v64, v49
  v_fmac_f32 v66, v65, v50
  v_fmac_f32 v67, v65, v48
  v_mul_f32 v70, v68, v51
  v_mul_f32 v71, v68, v52
  v_fmac_f32 v70, v69, v53
  v_fmac_f32 v71, v69, v51
  v_cvt_pk_bf16_f32 v72, v66, -v67
  v_cvt_pk_bf16_f32 v73, v70, v71
  ds_write_b32 v8, v72 offset:7616
  ds_write_b32 v8, v73 offset:3264
  v_mul_f32 v64, v66, v48
  v_mul_f32 v65, v66, v49
  v_fmac_f32 v64, v67, v50
  v_fmac_f32 v65, v67, v48
  v_mul_f32 v68, v70, v51
  v_mul_f32 v69, v70, v52
  v_fmac_f32 v68, v71, v53
  v_fmac_f32 v69, v71, v51
  v_cvt_pk_bf16_f32 v72, v64, -v65
  v_cvt_pk_bf16_f32 v73, v68, v69
  ds_write_b32 v8, v72 offset:7888
  ds_write_b32 v8, v73 offset:3536
  v_mul_f32 v66, v64, v48
  v_mul_f32 v67, v64, v49
  v_fmac_f32 v66, v65, v50
  v_fmac_f32 v67, v65, v48
  v_mul_f32 v70, v68, v51
  v_mul_f32 v71, v68, v52
  v_fmac_f32 v70, v69, v53
  v_fmac_f32 v71, v69, v51
  v_cvt_pk_bf16_f32 v72, v66, -v67
  v_cvt_pk_bf16_f32 v73, v70, v71
  ds_write_b32 v8, v72 offset:8160
  ds_write_b32 v8, v73 offset:3808
  v_mul_f32 v64, v66, v48
  v_mul_f32 v65, v66, v49
  v_fmac_f32 v64, v67, v50
  v_fmac_f32 v65, v67, v48
  v_mul_f32 v68, v70, v51
  v_mul_f32 v69, v70, v52
  v_fmac_f32 v68, v71, v53
  v_fmac_f32 v69, v71, v51
  v_cvt_pk_bf16_f32 v72, v64, -v65
  v_cvt_pk_bf16_f32 v73, v68, v69
  ds_write_b32 v8, v72 offset:8432
  ds_write_b32 v8, v73 offset:4080
  s_waitcnt lgkmcnt(0)
  ds_read_b128 v[76:79], v9 offset:0
  ds_read_b128 v[80:83], v9 offset:4352
  ds_read_b128 v[84:87], v9 offset:64
  ds_read_b128 v[88:91], v9 offset:4416
  ds_read_b128 v[92:95], v9 offset:128
  ds_read_b128 v[96:99], v9 offset:4480
  ds_read_b128 v[100:103], v9 offset:192
  ds_read_b128 v[104:107], v9 offset:4544
  s_waitcnt lgkmcnt(6)
  v_mfma_f32_16x16x32_bf16 v[40:43], v[76:79], v[80:83], v[40:43]
  s_waitcnt lgkmcnt(4)
  v_mfma_f32_16x16x32_bf16 v[40:43], v[84:87], v[88:91], v[40:43]
  s_waitcnt lgkmcnt(2)
  v_mfma_f32_16x16x32_bf16 v[40:43], v[92:95], v[96:99], v[40:43]
  s_waitcnt lgkmcnt(0)
  v_mfma_f32_16x16x32_bf16 v[40:43], v[100:103], v[104:107], v[40:43]
  v_lshlrev_b32 v20, 16, v20
  v_lshlrev_b32 v21, 16, v21
  v_lshlrev_b32 v22, 16, v22
  v_lshlrev_b32 v23, 16, v23
  v_mul_f32 v20, 0x3fb8aa3b, v20
  v_exp_f32 v20, v20
  s_nop 0
  v_cvt_pk_bf16_f32 v20, v20, v20
  v_lshlrev_b32 v20, 16, v20
  v_mul_f32 v20, v20, v24
  v_mul_f32 v44, 0xbfb8aa3b, v20
  v_mul_f32 v21, v21, v24
  v_mul_f32 v45, 0x3e22f983, v21
  v_mul_f32 v22, v22, v24
  v_add_f32 v46, v22, v22
  v_mul_f32 v23, v23, v24
  v_add_f32 v47, v23, v23

  v_mul_f32 v60, s88, v44
  v_mul_f32 v61, s88, v45
  v_exp_f32 v60, v60
  v_fract_f32 v61, v61
  v_cos_f32 v48, v61
  v_sin_f32 v49, v61
  s_nop 0
  v_mul_f32 v48, v60, v48
  v_mul_f32 v49, v60, v49

  v_mul_f32 v60, s89, v44
  v_mul_f32 v61, s89, v45
  v_exp_f32 v60, v60
  v_fract_f32 v61, v61
  v_cos_f32 v51, v61
  v_sin_f32 v52, v61
  s_nop 0
  v_mul_f32 v51, v60, v51
  v_mul_f32 v52, v60, v52

  v_mul_f32 v60, s90, v44
  v_mul_f32 v61, s90, v45
  v_exp_f32 v60, v60
  v_fract_f32 v61, v61
  v_cos_f32 v54, v61
  v_sin_f32 v55, v61
  s_nop 0
  v_mul_f32 v54, v60, v54
  v_mul_f32 v55, v60, v55

  v_sub_f32 v50, 0, v49
  v_sub_f32 v53, 0, v52
  v_sub_f32 v58, 0, v47

  v_mul_f32 v56, v54, v46
  v_mul_f32 v57, v54, v47
  v_fmac_f32 v56, v55, v58
  v_fmac_f32 v57, v55, v46
  s_waitcnt lgkmcnt(0)
  v_mov_b32 v72, 0x00003f80
  ds_write_b32 v8, v72 offset:4352
  v_cvt_pk_bf16_f32 v73, v56, v57
  ds_write_b32 v8, v73 offset:0
  v_mov_b32 v64, v48
  v_mov_b32 v65, v49
  v_mul_f32 v68, v56, v51
  v_mul_f32 v69, v56, v52
  v_fmac_f32 v68, v57, v53
  v_fmac_f32 v69, v57, v51
  v_cvt_pk_bf16_f32 v72, v64, -v65
  v_cvt_pk_bf16_f32 v73, v68, v69
  ds_write_b32 v8, v72 offset:4624
  ds_write_b32 v8, v73 offset:272
  v_mul_f32 v66, v64, v48
  v_mul_f32 v67, v64, v49
  v_fmac_f32 v66, v65, v50
  v_fmac_f32 v67, v65, v48
  v_mul_f32 v70, v68, v51
  v_mul_f32 v71, v68, v52
  v_fmac_f32 v70, v69, v53
  v_fmac_f32 v71, v69, v51
  v_cvt_pk_bf16_f32 v72, v66, -v67
  v_cvt_pk_bf16_f32 v73, v70, v71
  ds_write_b32 v8, v72 offset:4896
  ds_write_b32 v8, v73 offset:544
  v_mul_f32 v64, v66, v48
  v_mul_f32 v65, v66, v49
  v_fmac_f32 v64, v67, v50
  v_fmac_f32 v65, v67, v48
  v_mul_f32 v68, v70, v51
  v_mul_f32 v69, v70, v52
  v_fmac_f32 v68, v71, v53
  v_fmac_f32 v69, v71, v51
  v_cvt_pk_bf16_f32 v72, v64, -v65
  v_cvt_pk_bf16_f32 v73, v68, v69
  ds_write_b32 v8, v72 offset:5168
  ds_write_b32 v8, v73 offset:816
  v_mul_f32 v66, v64, v48
  v_mul_f32 v67, v64, v49
  v_fmac_f32 v66, v65, v50
  v_fmac_f32 v67, v65, v48
  v_mul_f32 v70, v68, v51
  v_mul_f32 v71, v68, v52
  v_fmac_f32 v70, v69, v53
  v_fmac_f32 v71, v69, v51
  v_cvt_pk_bf16_f32 v72, v66, -v67
  v_cvt_pk_bf16_f32 v73, v70, v71
  ds_write_b32 v8, v72 offset:5440
  ds_write_b32 v8, v73 offset:1088
  v_mul_f32 v64, v66, v48
  v_mul_f32 v65, v66, v49
  v_fmac_f32 v64, v67, v50
  v_fmac_f32 v65, v67, v48
  v_mul_f32 v68, v70, v51
  v_mul_f32 v69, v70, v52
  v_fmac_f32 v68, v71, v53
  v_fmac_f32 v69, v71, v51
  v_cvt_pk_bf16_f32 v72, v64, -v65
  v_cvt_pk_bf16_f32 v73, v68, v69
  ds_write_b32 v8, v72 offset:5712
  ds_write_b32 v8, v73 offset:1360
  v_mul_f32 v66, v64, v48
  v_mul_f32 v67, v64, v49
  v_fmac_f32 v66, v65, v50
  v_fmac_f32 v67, v65, v48
  v_mul_f32 v70, v68, v51
  v_mul_f32 v71, v68, v52
  v_fmac_f32 v70, v69, v53
  v_fmac_f32 v71, v69, v51
  v_cvt_pk_bf16_f32 v72, v66, -v67
  v_cvt_pk_bf16_f32 v73, v70, v71
  ds_write_b32 v8, v72 offset:5984
  ds_write_b32 v8, v73 offset:1632
  v_mul_f32 v64, v66, v48
  v_mul_f32 v65, v66, v49
  v_fmac_f32 v64, v67, v50
  v_fmac_f32 v65, v67, v48
  v_mul_f32 v68, v70, v51
  v_mul_f32 v69, v70, v52
  v_fmac_f32 v68, v71, v53
  v_fmac_f32 v69, v71, v51
  v_cvt_pk_bf16_f32 v72, v64, -v65
  v_cvt_pk_bf16_f32 v73, v68, v69
  ds_write_b32 v8, v72 offset:6256
  ds_write_b32 v8, v73 offset:1904
  v_mul_f32 v66, v64, v48
  v_mul_f32 v67, v64, v49
  v_fmac_f32 v66, v65, v50
  v_fmac_f32 v67, v65, v48
  v_mul_f32 v70, v68, v51
  v_mul_f32 v71, v68, v52
  v_fmac_f32 v70, v69, v53
  v_fmac_f32 v71, v69, v51
  v_cvt_pk_bf16_f32 v72, v66, -v67
  v_cvt_pk_bf16_f32 v73, v70, v71
  ds_write_b32 v8, v72 offset:6528
  ds_write_b32 v8, v73 offset:2176
  v_mul_f32 v64, v66, v48
  v_mul_f32 v65, v66, v49
  v_fmac_f32 v64, v67, v50
  v_fmac_f32 v65, v67, v48
  v_mul_f32 v68, v70, v51
  v_mul_f32 v69, v70, v52
  v_fmac_f32 v68, v71, v53
  v_fmac_f32 v69, v71, v51
  v_cvt_pk_bf16_f32 v72, v64, -v65
  v_cvt_pk_bf16_f32 v73, v68, v69
  ds_write_b32 v8, v72 offset:6800
  ds_write_b32 v8, v73 offset:2448
  v_mul_f32 v66, v64, v48
  v_mul_f32 v67, v64, v49
  v_fmac_f32 v66, v65, v50
  v_fmac_f32 v67, v65, v48
  v_mul_f32 v70, v68, v51
  v_mul_f32 v71, v68, v52
  v_fmac_f32 v70, v69, v53
  v_fmac_f32 v71, v69, v51
  v_cvt_pk_bf16_f32 v72, v66, -v67
  v_cvt_pk_bf16_f32 v73, v70, v71
  ds_write_b32 v8, v72 offset:7072
  ds_write_b32 v8, v73 offset:2720
  v_mul_f32 v64, v66, v48
  v_mul_f32 v65, v66, v49
  v_fmac_f32 v64, v67, v50
  v_fmac_f32 v65, v67, v48
  v_mul_f32 v68, v70, v51
  v_mul_f32 v69, v70, v52
  v_fmac_f32 v68, v71, v53
  v_fmac_f32 v69, v71, v51
  v_cvt_pk_bf16_f32 v72, v64, -v65
  v_cvt_pk_bf16_f32 v73, v68, v69
  ds_write_b32 v8, v72 offset:7344
  ds_write_b32 v8, v73 offset:2992
  v_mul_f32 v66, v64, v48
  v_mul_f32 v67, v64, v49
  v_fmac_f32 v66, v65, v50
  v_fmac_f32 v67, v65, v48
  v_mul_f32 v70, v68, v51
  v_mul_f32 v71, v68, v52
  v_fmac_f32 v70, v69, v53
  v_fmac_f32 v71, v69, v51
  v_cvt_pk_bf16_f32 v72, v66, -v67
  v_cvt_pk_bf16_f32 v73, v70, v71
  ds_write_b32 v8, v72 offset:7616
  ds_write_b32 v8, v73 offset:3264
  v_mul_f32 v64, v66, v48
  v_mul_f32 v65, v66, v49
  v_fmac_f32 v64, v67, v50
  v_fmac_f32 v65, v67, v48
  v_mul_f32 v68, v70, v51
  v_mul_f32 v69, v70, v52
  v_fmac_f32 v68, v71, v53
  v_fmac_f32 v69, v71, v51
  v_cvt_pk_bf16_f32 v72, v64, -v65
  v_cvt_pk_bf16_f32 v73, v68, v69
  ds_write_b32 v8, v72 offset:7888
  ds_write_b32 v8, v73 offset:3536
  v_mul_f32 v66, v64, v48
  v_mul_f32 v67, v64, v49
  v_fmac_f32 v66, v65, v50
  v_fmac_f32 v67, v65, v48
  v_mul_f32 v70, v68, v51
  v_mul_f32 v71, v68, v52
  v_fmac_f32 v70, v69, v53
  v_fmac_f32 v71, v69, v51
  v_cvt_pk_bf16_f32 v72, v66, -v67
  v_cvt_pk_bf16_f32 v73, v70, v71
  ds_write_b32 v8, v72 offset:8160
  ds_write_b32 v8, v73 offset:3808
  v_mul_f32 v64, v66, v48
  v_mul_f32 v65, v66, v49
  v_fmac_f32 v64, v67, v50
  v_fmac_f32 v65, v67, v48
  v_mul_f32 v68, v70, v51
  v_mul_f32 v69, v70, v52
  v_fmac_f32 v68, v71, v53
  v_fmac_f32 v69, v71, v51
  v_cvt_pk_bf16_f32 v72, v64, -v65
  v_cvt_pk_bf16_f32 v73, v68, v69
  ds_write_b32 v8, v72 offset:8432
  ds_write_b32 v8, v73 offset:4080
  s_waitcnt lgkmcnt(0)
  ds_read_b128 v[76:79], v9 offset:0
  ds_read_b128 v[80:83], v9 offset:4352
  ds_read_b128 v[84:87], v9 offset:64
  ds_read_b128 v[88:91], v9 offset:4416
  ds_read_b128 v[92:95], v9 offset:128
  ds_read_b128 v[96:99], v9 offset:4480
  ds_read_b128 v[100:103], v9 offset:192
  ds_read_b128 v[104:107], v9 offset:4544
  s_waitcnt lgkmcnt(6)
  v_mfma_f32_16x16x32_bf16 v[40:43], v[76:79], v[80:83], v[40:43]
  s_waitcnt lgkmcnt(4)
  v_mfma_f32_16x16x32_bf16 v[40:43], v[84:87], v[88:91], v[40:43]
  s_waitcnt lgkmcnt(2)
  v_mfma_f32_16x16x32_bf16 v[40:43], v[92:95], v[96:99], v[40:43]
  s_waitcnt lgkmcnt(0)
  v_mfma_f32_16x16x32_bf16 v[40:43], v[100:103], v[104:107], v[40:43]
  s_nop 7

  s_nop 4
  s_lshl_b32 s7, s3, 7
  s_lshl_b32 s8, s6, 4
  s_add_u32 s7, s7, s8
  v_lshl_add_u32 v9, v5, 6, v4
  v_add_u32 v9, s7, v9
  v_lshlrev_b32 v9, 1, v9
  v_cvt_pk_bf16_f32 v44, v40, v41
  v_cvt_pk_bf16_f32 v45, v42, v43
  s_cmp_eq_u32 s3, 0
  s_cbranch_scc1 K0_TW_ALL
  s_cmp_eq_u32 s3, 3
  s_cbranch_scc0 K0_TW_HALF
  s_mov_b32 exec_lo, 0
  s_mov_b32 exec_hi, 0xffff
  ds_write_b16 v9, v44 offset:34816
  K0_TW_HALF:
  s_mov_b32 exec_lo, -1
  s_mov_b32 exec_hi, 0
  K0_TW_ALL:
  ds_write_b16 v9, v44 offset:34816
  ds_write_b16_d16_hi v9, v44 offset:34848
  ds_write_b16 v9, v45 offset:34880
  ds_write_b16_d16_hi v9, v45 offset:34912
  s_mov_b64 exec, -1
  s_waitcnt lgkmcnt(0)
  s_barrier

  v_mov_b32 v12, 700
  s_mul_i32 s101, s2, 4224
  s_add_u32 s101, s101, 29360128
  s_movk_i32 s100, 128
  v_mov_b32 v10, v0
  v_lshlrev_b32 v11, 3, v10
  v_sub_u32 v11, 2048, v11

  v_mov_b32 v16, v11
  v_subrev_u32 v17, 1, v11
  v_subrev_u32 v18, 2, v11
  v_subrev_u32 v19, 3, v11
  v_subrev_u32 v20, 4, v11
  v_subrev_u32 v21, 5, v11
  v_subrev_u32 v22, 6, v11
  v_subrev_u32 v23, 7, v11
  v_cvt_f32_i32 v24, v16
  v_cvt_f32_i32 v25, v17
  v_cvt_f32_i32 v26, v18
  v_cvt_f32_i32 v27, v19
  v_cvt_f32_i32 v28, v20
  v_cvt_f32_i32 v29, v21
  v_cvt_f32_i32 v30, v22
  v_cvt_f32_i32 v31, v23
  v_cvt_pk_bf16_f32 v32, v24, v25
  v_cvt_pk_bf16_f32 v33, v26, v27
  v_cvt_pk_bf16_f32 v34, v28, v29
  v_cvt_pk_bf16_f32 v35, v30, v31
  v_and_b32 v24, 0xffff, v32
  v_subrev_u32 v24, 17024, v24
  v_lshrrev_b32 v25, 16, v32
  v_subrev_u32 v25, 17024, v25
  v_and_b32 v26, 0xffff, v33
  v_subrev_u32 v26, 17024, v26
  v_lshrrev_b32 v27, 16, v33
  v_subrev_u32 v27, 17024, v27
  v_and_b32 v28, 0xffff, v34
  v_subrev_u32 v28, 17024, v28
  v_lshrrev_b32 v29, 16, v34
  v_subrev_u32 v29, 17024, v29
  v_and_b32 v30, 0xffff, v35
  v_subrev_u32 v30, 17024, v30
  v_lshrrev_b32 v31, 16, v35
  v_subrev_u32 v31, 17024, v31
  v_cmp_gt_i32 s[92:93], s100, v16
  v_cmp_gt_i32 s[94:95], s100, v17
  v_cmp_gt_i32 s[96:97], s100, v18
  v_cmp_gt_i32 s[98:99], s100, v19
  v_cndmask_b32 v24, v24, v16, s[92:93]
  v_cndmask_b32 v25, v25, v17, s[94:95]
  v_cndmask_b32 v26, v26, v18, s[96:97]
  v_cndmask_b32 v27, v27, v19, s[98:99]
  v_cmp_gt_i32 s[92:93], s100, v20
  v_cmp_gt_i32 s[94:95], s100, v21
  v_cmp_gt_i32 s[96:97], s100, v22
  v_cmp_gt_i32 s[98:99], s100, v23
  v_cndmask_b32 v28, v28, v20, s[92:93]
  v_cndmask_b32 v29, v29, v21, s[94:95]
  v_cndmask_b32 v30, v30, v22, s[96:97]
  v_cndmask_b32 v31, v31, v23, s[98:99]
  v_lshlrev_b32 v24, 1, v24
  v_lshlrev_b32 v25, 1, v25
  v_lshlrev_b32 v26, 1, v26
  v_lshlrev_b32 v27, 1, v27
  v_lshlrev_b32 v28, 1, v28
  v_lshlrev_b32 v29, 1, v29
  v_lshlrev_b32 v30, 1, v30
  v_lshlrev_b32 v31, 1, v31
  ds_read_u16 v16, v24 offset:34816
  ds_read_u16 v17, v25 offset:34816
  ds_read_u16 v18, v26 offset:34816
  ds_read_u16 v19, v27 offset:34816
  ds_read_u16 v20, v28 offset:34816
  ds_read_u16 v21, v29 offset:34816
  ds_read_u16 v22, v30 offset:34816
  ds_read_u16 v23, v31 offset:34816
  v_lshlrev_b32 v13, 4, v10
  s_waitcnt lgkmcnt(0)
  v_lshl_or_b32 v36, v17, 16, v16
  v_lshl_or_b32 v37, v19, 16, v18
  v_lshl_or_b32 v38, v21, 16, v20
  v_lshl_or_b32 v39, v23, 16, v22
  buffer_store_dwordx4 v[36:39], v13, s[56:59], s101 offen sc1

  v_cmp_gt_u32 vcc, 5, v0
  s_and_saveexec_b64 s[12:13], vcc
  s_cbranch_execz K0_D1_SKIP

  v_add_u32 v10, 256, v0
  v_lshlrev_b32 v11, 3, v10
  v_sub_u32 v11, 2048, v11

  v_mov_b32 v16, v11
  v_subrev_u32 v17, 1, v11
  v_subrev_u32 v18, 2, v11
  v_subrev_u32 v19, 3, v11
  v_subrev_u32 v20, 4, v11
  v_subrev_u32 v21, 5, v11
  v_subrev_u32 v22, 6, v11
  v_subrev_u32 v23, 7, v11
  v_cvt_f32_i32 v24, v16
  v_cvt_f32_i32 v25, v17
  v_cvt_f32_i32 v26, v18
  v_cvt_f32_i32 v27, v19
  v_cvt_f32_i32 v28, v20
  v_cvt_f32_i32 v29, v21
  v_cvt_f32_i32 v30, v22
  v_cvt_f32_i32 v31, v23
  v_cvt_pk_bf16_f32 v32, v24, v25
  v_cvt_pk_bf16_f32 v33, v26, v27
  v_cvt_pk_bf16_f32 v34, v28, v29
  v_cvt_pk_bf16_f32 v35, v30, v31
  v_and_b32 v24, 0xffff, v32
  v_subrev_u32 v24, 17024, v24
  v_lshrrev_b32 v25, 16, v32
  v_subrev_u32 v25, 17024, v25
  v_and_b32 v26, 0xffff, v33
  v_subrev_u32 v26, 17024, v26
  v_lshrrev_b32 v27, 16, v33
  v_subrev_u32 v27, 17024, v27
  v_and_b32 v28, 0xffff, v34
  v_subrev_u32 v28, 17024, v28
  v_lshrrev_b32 v29, 16, v34
  v_subrev_u32 v29, 17024, v29
  v_and_b32 v30, 0xffff, v35
  v_subrev_u32 v30, 17024, v30
  v_lshrrev_b32 v31, 16, v35
  v_subrev_u32 v31, 17024, v31
  v_cmp_gt_i32 s[92:93], s100, v16
  v_cmp_gt_i32 s[94:95], s100, v17
  v_cmp_gt_i32 s[96:97], s100, v18
  v_cmp_gt_i32 s[98:99], s100, v19
  v_cndmask_b32 v24, v24, v16, s[92:93]
  v_cndmask_b32 v25, v25, v17, s[94:95]
  v_cndmask_b32 v26, v26, v18, s[96:97]
  v_cndmask_b32 v27, v27, v19, s[98:99]
  v_cmp_gt_i32 s[92:93], s100, v20
  v_cmp_gt_i32 s[94:95], s100, v21
  v_cmp_gt_i32 s[96:97], s100, v22
  v_cmp_gt_i32 s[98:99], s100, v23
  v_cndmask_b32 v28, v28, v20, s[92:93]
  v_cndmask_b32 v29, v29, v21, s[94:95]
  v_cndmask_b32 v30, v30, v22, s[96:97]
  v_cndmask_b32 v31, v31, v23, s[98:99]
  v_cmp_gt_i32 vcc, 0, v16
  s_nop 1
  v_cndmask_b32 v24, v24, v12, vcc
  v_cmp_gt_i32 vcc, 0, v17
  s_nop 1
  v_cndmask_b32 v25, v25, v12, vcc
  v_cmp_gt_i32 vcc, 0, v18
  s_nop 1
  v_cndmask_b32 v26, v26, v12, vcc
  v_cmp_gt_i32 vcc, 0, v19
  s_nop 1
  v_cndmask_b32 v27, v27, v12, vcc
  v_cmp_gt_i32 vcc, 0, v20
  s_nop 1
  v_cndmask_b32 v28, v28, v12, vcc
  v_cmp_gt_i32 vcc, 0, v21
  s_nop 1
  v_cndmask_b32 v29, v29, v12, vcc
  v_cmp_gt_i32 vcc, 0, v22
  s_nop 1
  v_cndmask_b32 v30, v30, v12, vcc
  v_cmp_gt_i32 vcc, 0, v23
  s_nop 1
  v_cndmask_b32 v31, v31, v12, vcc
  v_lshlrev_b32 v24, 1, v24
  v_lshlrev_b32 v25, 1, v25
  v_lshlrev_b32 v26, 1, v26
  v_lshlrev_b32 v27, 1, v27
  v_lshlrev_b32 v28, 1, v28
  v_lshlrev_b32 v29, 1, v29
  v_lshlrev_b32 v30, 1, v30
  v_lshlrev_b32 v31, 1, v31
  ds_read_u16 v16, v24 offset:34816
  ds_read_u16 v17, v25 offset:34816
  ds_read_u16 v18, v26 offset:34816
  ds_read_u16 v19, v27 offset:34816
  ds_read_u16 v20, v28 offset:34816
  ds_read_u16 v21, v29 offset:34816
  ds_read_u16 v22, v30 offset:34816
  ds_read_u16 v23, v31 offset:34816
  v_lshlrev_b32 v13, 4, v10
  s_waitcnt lgkmcnt(0)
  v_lshl_or_b32 v36, v17, 16, v16
  v_lshl_or_b32 v37, v19, 16, v18
  v_lshl_or_b32 v38, v21, 16, v20
  v_lshl_or_b32 v39, v23, 16, v22
  buffer_store_dwordx4 v[36:39], v13, s[56:59], s101 offen sc1

  K0_D1_SKIP:
  s_endpgm

.globl k1_kernel
.p2align 8
.type k1_kernel,@function
k1_kernel:
  s_cmp_ge_u32 s2, 848
  s_cbranch_scc1 K1_END
  s_load_dwordx16 s[16:31], s[0:1], 0
  s_load_dwordx16 s[32:47], s[0:1], 64
  v_and_b32 v2, 63, v0
  v_lshrrev_b32 v1, 6, v0
  s_nop 0
  v_readfirstlane_b32 s3, v1
  s_waitcnt lgkmcnt(0)
  s_cmp_ge_u32 s2, 272
  s_cbranch_scc1 K1_CONV
  s_sub_u32 s2, s2, 16
  s_cmp_lt_i32 s2, 0
  s_cselect_b32 s8, 272, 0
  s_add_u32 s2, s2, s8

  s_mov_b32 s56, s46
  s_and_b32 s57, s47, 0xffff
  s_mov_b32 s58, 268435456
  s_mov_b32 s59, 0x00020000
  v_and_b32 v5, 31, v2
  v_lshrrev_b32 v6, 5, v2
  v_lshlrev_b32 v7, 4, v2
  s_lshl_b32 s4, s2, 2
  s_add_u32 s4, s4, s3
  s_cmp_lt_u32 s2, 256
  s_cbranch_scc0 K1_KV
  s_and_b32 s7, s2, 7
  s_lshr_b32 s8, s2, 3
  s_lshr_b32 s5, s8, 4
  s_lshl_b32 s7, s7, 1
  s_add_u32 s5, s5, s7
  s_lshl_b32 s5, s5, 2
  s_add_u32 s5, s5, s3
  s_and_b32 s6, s8, 15
  s_mul_i32 s80, s5, 36864
  s_add_u32 s80, s80, 16777216
  s_lshl_b32 s10, s3, 10
  s_mul_i32 s84, s6, 73728
  s_add_u32 s84, s84, 23068672
  s_add_u32 s84, s84, s10
  s_add_u32 s85, s84, 36864

  s_mov_b32 s93, s84
  s_add_u32 s94, s84, 4096
  s_sub_u32 s95, s85, 2048
  s_cmp_lt_u32 s3, 2
  s_cselect_b32 s94, s94, s95
  s_add_u32 s95, s85, 2048
  s_add_u32 s86, s10, 0
  v_mov_b32 v15, v7

  s_add_u32 m0, s86, 0
  s_nop 0
  buffer_load_dwordx4 v7, s[56:59], s93 offen lds
  s_add_u32 s93, s93, 6144
  s_add_u32 m0, s86, 4096
  s_nop 0
  buffer_load_dwordx4 v7, s[56:59], s94 offen lds
  s_add_u32 s94, s94, 6144
  s_add_u32 m0, s86, 8192
  s_nop 0
  buffer_load_dwordx4 v7, s[56:59], s95 offen lds
  s_add_u32 s95, s95, 6144
  buffer_load_dwordx4 v[80:83], v7, s[56:59], s80 offen
  s_add_u32 s80, s80, 1024
  buffer_load_dwordx4 v[84:87], v7, s[56:59], s80 offen
  s_add_u32 s80, s80, 1024
  buffer_load_dwordx4 v[88:91], v7, s[56:59], s80 offen
  s_add_u32 s80, s80, 1024
  buffer_load_dwordx4 v[92:95], v7, s[56:59], s80 offen
  s_add_u32 s80, s80, 1024
  buffer_load_dwordx4 v[96:99], v7, s[56:59], s80 offen
  s_add_u32 s80, s80, 1024
  v_mov_b32 v16, 0
  v_mov_b32 v17, 0
  v_mov_b32 v18, 0
  v_mov_b32 v19, 0
  v_mov_b32 v20, 0
  v_mov_b32 v21, 0
  v_mov_b32 v22, 0
  v_mov_b32 v23, 0
  v_mov_b32 v24, 0
  v_mov_b32 v25, 0
  v_mov_b32 v26, 0
  v_mov_b32 v27, 0
  v_mov_b32 v28, 0
  v_mov_b32 v29, 0
  v_mov_b32 v30, 0
  v_mov_b32 v31, 0
  v_mov_b32 v32, 0
  v_mov_b32 v33, 0
  v_mov_b32 v34, 0
  v_mov_b32 v35, 0
  v_mov_b32 v36, 0
  v_mov_b32 v37, 0
  v_mov_b32 v38, 0
  v_mov_b32 v39, 0
  v_mov_b32 v40, 0
  v_mov_b32 v41, 0
  v_mov_b32 v42, 0
  v_mov_b32 v43, 0
  v_mov_b32 v44, 0
  v_mov_b32 v45, 0
  v_mov_b32 v46, 0
  v_mov_b32 v47, 0
  s_xor_b32 s86, s86, 12288
  s_mov_b32 s87, 6
  s_waitcnt vmcnt(5)
  s_barrier
  ds_read_b128 v[104:107], v15 offset:0
  ds_read_b128 v[108:111], v15 offset:6144
K1_QL:
  s_add_u32 m0, s86, 0
  s_nop 0
  buffer_load_dwordx4 v7, s[56:59], s93 offen lds
  s_add_u32 s93, s93, 6144
  ds_read_b128 v[112:115], v15 offset:1024
  ds_read_b128 v[116:119], v15 offset:7168
  buffer_load_dwordx4 v[100:103], v7, s[56:59], s80 offen
  s_add_u32 s80, s80, 1024
  s_waitcnt vmcnt(6) lgkmcnt(2)
  v_mfma_f32_32x32x16_bf16 v[16:31], v[104:107], v[80:83], v[16:31]
  v_mfma_f32_32x32x16_bf16 v[32:47], v[108:111], v[80:83], v[32:47]
  s_add_u32 m0, s86, 4096
  s_nop 0
  buffer_load_dwordx4 v7, s[56:59], s94 offen lds
  s_add_u32 s94, s94, 6144
  ds_read_b128 v[104:107], v15 offset:2048
  ds_read_b128 v[108:111], v15 offset:8192
  buffer_load_dwordx4 v[80:83], v7, s[56:59], s80 offen
  s_add_u32 s80, s80, 1024
  s_waitcnt vmcnt(7) lgkmcnt(2)
  v_mfma_f32_32x32x16_bf16 v[16:31], v[112:115], v[84:87], v[16:31]
  v_mfma_f32_32x32x16_bf16 v[32:47], v[116:119], v[84:87], v[32:47]
  s_add_u32 m0, s86, 8192
  s_nop 0
  buffer_load_dwordx4 v7, s[56:59], s95 offen lds
  s_add_u32 s95, s95, 6144
  ds_read_b128 v[112:115], v15 offset:3072
  ds_read_b128 v[116:119], v15 offset:9216
  buffer_load_dwordx4 v[84:87], v7, s[56:59], s80 offen
  s_add_u32 s80, s80, 1024
  s_waitcnt vmcnt(8) lgkmcnt(2)
  v_mfma_f32_32x32x16_bf16 v[16:31], v[104:107], v[88:91], v[16:31]
  v_mfma_f32_32x32x16_bf16 v[32:47], v[108:111], v[88:91], v[32:47]
  ds_read_b128 v[104:107], v15 offset:4096
  ds_read_b128 v[108:111], v15 offset:10240
  buffer_load_dwordx4 v[88:91], v7, s[56:59], s80 offen
  s_add_u32 s80, s80, 1024
  s_waitcnt vmcnt(8) lgkmcnt(2)
  v_mfma_f32_32x32x16_bf16 v[16:31], v[112:115], v[92:95], v[16:31]
  v_mfma_f32_32x32x16_bf16 v[32:47], v[116:119], v[92:95], v[32:47]
  ds_read_b128 v[112:115], v15 offset:5120
  ds_read_b128 v[116:119], v15 offset:11264
  buffer_load_dwordx4 v[92:95], v7, s[56:59], s80 offen
  s_add_u32 s80, s80, 1024
  s_waitcnt vmcnt(8) lgkmcnt(2)
  v_mfma_f32_32x32x16_bf16 v[16:31], v[104:107], v[96:99], v[16:31]
  v_mfma_f32_32x32x16_bf16 v[32:47], v[108:111], v[96:99], v[32:47]
  s_waitcnt vmcnt(3) lgkmcnt(0)
  s_barrier
  v_xor_b32 v15, 12288, v15
  s_xor_b32 s86, s86, 12288
  ds_read_b128 v[104:107], v15 offset:0
  ds_read_b128 v[108:111], v15 offset:6144
  buffer_load_dwordx4 v[96:99], v7, s[56:59], s80 offen
  s_add_u32 s80, s80, 1024
  s_waitcnt vmcnt(7) lgkmcnt(2)
  v_mfma_f32_32x32x16_bf16 v[16:31], v[112:115], v[100:103], v[16:31]
  v_mfma_f32_32x32x16_bf16 v[32:47], v[116:119], v[100:103], v[32:47]
  s_sub_u32 s87, s87, 1
  s_cmp_lg_u32 s87, 0
  s_cbranch_scc1 K1_QL
  s_waitcnt vmcnt(0) lgkmcnt(0)
  s_nop 15

  s_mov_b32 s9, 0x3eae1a93
  v_mul_f32 v16, s9, v16
  v_mul_f32 v17, s9, v17
  v_mul_f32 v18, s9, v18
  v_mul_f32 v19, s9, v19
  v_mul_f32 v20, s9, v20
  v_mul_f32 v21, s9, v21
  v_mul_f32 v22, s9, v22
  v_mul_f32 v23, s9, v23
  v_mul_f32 v24, s9, v24
  v_mul_f32 v25, s9, v25
  v_mul_f32 v32, s9, v32
  v_mul_f32 v33, s9, v33
  v_mul_f32 v34, s9, v34
  v_mul_f32 v35, s9, v35
  v_mul_f32 v36, s9, v36
  v_mul_f32 v37, s9, v37
  v_mul_f32 v38, s9, v38
  v_mul_f32 v39, s9, v39
  v_mul_f32 v40, s9, v40
  v_mul_f32 v41, s9, v41
  v_cmp_gt_u32 vcc, 32, v2
  v_mov_b32 v101, 0
  v_mov_b32 v102, 0
  v_mov_b32 v103, 0
  v_mov_b32 v109, 0
  v_mov_b32 v110, 0
  v_mov_b32 v111, 0
  s_lshl_b32 s9, s6, 7
  s_add_u32 s9, s9, s5
  s_lshl_b32 s9, s9, 11

  v_cvt_pk_bf16_f32 v96, v16, v17
  v_cvt_pk_bf16_f32 v97, v18, v19
  v_cvt_pk_bf16_f32 v98, v20, v21
  v_cvt_pk_bf16_f32 v99, v22, v23
  v_cvt_pk_bf16_f32 v100, v24, v25
  v_cndmask_b32 v100, 0, v100, vcc
  s_add_u32 s12, s9, 0
  buffer_store_dwordx4 v[96:99], v7, s[56:59], s12 offen sc1
  buffer_store_dwordx4 v[100:103], v7, s[56:59], s12 offen offset:1024 sc1
  v_cvt_pk_bf16_f32 v104, v32, v33
  v_cvt_pk_bf16_f32 v105, v34, v35
  v_cvt_pk_bf16_f32 v106, v36, v37
  v_cvt_pk_bf16_f32 v107, v38, v39
  v_cvt_pk_bf16_f32 v108, v40, v41
  v_cndmask_b32 v108, 0, v108, vcc
  s_add_u32 s12, s9, 131072
  buffer_store_dwordx4 v[104:107], v7, s[56:59], s12 offen sc1
  buffer_store_dwordx4 v[108:111], v7, s[56:59], s12 offen offset:1024 sc1
  s_endpgm
K1_KV:
  s_sub_u32 s5, s4, 1024
  s_mul_i32 s80, s5, 36864
  s_add_u32 s80, s80, 16777216
  s_lshl_b32 s10, s3, 10
  s_add_u32 s84, s10, 25165824
  s_add_u32 s85, s10, 25231360

  s_mov_b32 s93, s84
  s_add_u32 s94, s84, 4096
  s_sub_u32 s95, s85, 2048
  s_cmp_lt_u32 s3, 2
  s_cselect_b32 s94, s94, s95
  s_add_u32 s95, s85, 2048
  s_add_u32 s86, s10, 0
  v_mov_b32 v15, v7

  s_add_u32 m0, s86, 0
  s_nop 0
  buffer_load_dwordx4 v7, s[56:59], s93 offen lds
  s_add_u32 s93, s93, 6144
  s_add_u32 m0, s86, 4096
  s_nop 0
  buffer_load_dwordx4 v7, s[56:59], s94 offen lds
  s_add_u32 s94, s94, 6144
  s_add_u32 m0, s86, 8192
  s_nop 0
  buffer_load_dwordx4 v7, s[56:59], s95 offen lds
  s_add_u32 s95, s95, 6144
  buffer_load_dwordx4 v[80:83], v7, s[56:59], s80 offen
  s_add_u32 s80, s80, 1024
  buffer_load_dwordx4 v[84:87], v7, s[56:59], s80 offen
  s_add_u32 s80, s80, 1024
  buffer_load_dwordx4 v[88:91], v7, s[56:59], s80 offen
  s_add_u32 s80, s80, 1024
  buffer_load_dwordx4 v[92:95], v7, s[56:59], s80 offen
  s_add_u32 s80, s80, 1024
  buffer_load_dwordx4 v[96:99], v7, s[56:59], s80 offen
  s_add_u32 s80, s80, 1024
  v_mov_b32 v16, 0
  v_mov_b32 v17, 0
  v_mov_b32 v18, 0
  v_mov_b32 v19, 0
  v_mov_b32 v20, 0
  v_mov_b32 v21, 0
  v_mov_b32 v22, 0
  v_mov_b32 v23, 0
  v_mov_b32 v24, 0
  v_mov_b32 v25, 0
  v_mov_b32 v26, 0
  v_mov_b32 v27, 0
  v_mov_b32 v28, 0
  v_mov_b32 v29, 0
  v_mov_b32 v30, 0
  v_mov_b32 v31, 0
  v_mov_b32 v32, 0
  v_mov_b32 v33, 0
  v_mov_b32 v34, 0
  v_mov_b32 v35, 0
  v_mov_b32 v36, 0
  v_mov_b32 v37, 0
  v_mov_b32 v38, 0
  v_mov_b32 v39, 0
  v_mov_b32 v40, 0
  v_mov_b32 v41, 0
  v_mov_b32 v42, 0
  v_mov_b32 v43, 0
  v_mov_b32 v44, 0
  v_mov_b32 v45, 0
  v_mov_b32 v46, 0
  v_mov_b32 v47, 0
  s_xor_b32 s86, s86, 12288
  s_mov_b32 s87, 6
  s_waitcnt vmcnt(5)
  s_barrier
  ds_read_b128 v[104:107], v15 offset:0
  ds_read_b128 v[108:111], v15 offset:6144
K1_KL:
  s_add_u32 m0, s86, 0
  s_nop 0
  buffer_load_dwordx4 v7, s[56:59], s93 offen lds
  s_add_u32 s93, s93, 6144
  ds_read_b128 v[112:115], v15 offset:1024
  ds_read_b128 v[116:119], v15 offset:7168
  buffer_load_dwordx4 v[100:103], v7, s[56:59], s80 offen
  s_add_u32 s80, s80, 1024
  s_waitcnt vmcnt(6) lgkmcnt(2)
  v_mfma_f32_32x32x16_bf16 v[16:31], v[104:107], v[80:83], v[16:31]
  v_mfma_f32_32x32x16_bf16 v[32:47], v[80:83], v[108:111], v[32:47]
  s_add_u32 m0, s86, 4096
  s_nop 0
  buffer_load_dwordx4 v7, s[56:59], s94 offen lds
  s_add_u32 s94, s94, 6144
  ds_read_b128 v[104:107], v15 offset:2048
  ds_read_b128 v[108:111], v15 offset:8192
  buffer_load_dwordx4 v[80:83], v7, s[56:59], s80 offen
  s_add_u32 s80, s80, 1024
  s_waitcnt vmcnt(7) lgkmcnt(2)
  v_mfma_f32_32x32x16_bf16 v[16:31], v[112:115], v[84:87], v[16:31]
  v_mfma_f32_32x32x16_bf16 v[32:47], v[84:87], v[116:119], v[32:47]
  s_add_u32 m0, s86, 8192
  s_nop 0
  buffer_load_dwordx4 v7, s[56:59], s95 offen lds
  s_add_u32 s95, s95, 6144
  ds_read_b128 v[112:115], v15 offset:3072
  ds_read_b128 v[116:119], v15 offset:9216
  buffer_load_dwordx4 v[84:87], v7, s[56:59], s80 offen
  s_add_u32 s80, s80, 1024
  s_waitcnt vmcnt(8) lgkmcnt(2)
  v_mfma_f32_32x32x16_bf16 v[16:31], v[104:107], v[88:91], v[16:31]
  v_mfma_f32_32x32x16_bf16 v[32:47], v[88:91], v[108:111], v[32:47]
  ds_read_b128 v[104:107], v15 offset:4096
  ds_read_b128 v[108:111], v15 offset:10240
  buffer_load_dwordx4 v[88:91], v7, s[56:59], s80 offen
  s_add_u32 s80, s80, 1024
  s_waitcnt vmcnt(8) lgkmcnt(2)
  v_mfma_f32_32x32x16_bf16 v[16:31], v[112:115], v[92:95], v[16:31]
  v_mfma_f32_32x32x16_bf16 v[32:47], v[92:95], v[116:119], v[32:47]
  ds_read_b128 v[112:115], v15 offset:5120
  ds_read_b128 v[116:119], v15 offset:11264
  buffer_load_dwordx4 v[92:95], v7, s[56:59], s80 offen
  s_add_u32 s80, s80, 1024
  s_waitcnt vmcnt(8) lgkmcnt(2)
  v_mfma_f32_32x32x16_bf16 v[16:31], v[104:107], v[96:99], v[16:31]
  v_mfma_f32_32x32x16_bf16 v[32:47], v[96:99], v[108:111], v[32:47]
  s_waitcnt vmcnt(3) lgkmcnt(0)
  s_barrier
  v_xor_b32 v15, 12288, v15
  s_xor_b32 s86, s86, 12288
  ds_read_b128 v[104:107], v15 offset:0
  ds_read_b128 v[108:111], v15 offset:6144
  buffer_load_dwordx4 v[96:99], v7, s[56:59], s80 offen
  s_add_u32 s80, s80, 1024
  s_waitcnt vmcnt(7) lgkmcnt(2)
  v_mfma_f32_32x32x16_bf16 v[16:31], v[112:115], v[100:103], v[16:31]
  v_mfma_f32_32x32x16_bf16 v[32:47], v[100:103], v[116:119], v[32:47]
  s_sub_u32 s87, s87, 1
  s_cmp_lg_u32 s87, 0
  s_cbranch_scc1 K1_KL
  s_waitcnt vmcnt(0) lgkmcnt(0)
  s_nop 15

  s_lshr_b32 s9, s5, 3
  s_mul_i32 s9, s9, 19456
  s_add_u32 s9, s9, 4194304
  s_and_b32 s10, s5, 7
  s_lshl_b32 s11, s10, 10
  s_add_u32 s11, s11, s9

  v_cvt_pk_bf16_f32 v96, v16, v17
  v_cvt_pk_bf16_f32 v97, v18, v19
  v_cvt_pk_bf16_f32 v98, v20, v21
  v_cvt_pk_bf16_f32 v99, v22, v23
  v_cvt_pk_bf16_f32 v100, v24, v25
  buffer_store_dwordx4 v[96:99], v7, s[56:59], s11 offen sc1
  v_cvt_pk_bf16_f32 v104, v32, v33
  v_cvt_pk_bf16_f32 v105, v34, v35
  v_cvt_pk_bf16_f32 v106, v36, v37
  v_cvt_pk_bf16_f32 v107, v38, v39
  v_cvt_pk_bf16_f32 v108, v40, v41
  v_cvt_pk_bf16_f32 v109, v42, v43
  v_cvt_pk_bf16_f32 v110, v44, v45
  v_cvt_pk_bf16_f32 v111, v46, v47
  v_mov_b32 v10, 0x3f803f80
  v_cmp_eq_u32 vcc, 18, v5
  s_nop 1

  v_cndmask_b32 v104, v104, v10, vcc
  v_cndmask_b32 v105, v105, v10, vcc
  v_cndmask_b32 v106, v106, v10, vcc
  v_cndmask_b32 v107, v107, v10, vcc
  v_cndmask_b32 v108, v108, v10, vcc
  v_cndmask_b32 v109, v109, v10, vcc
  v_cndmask_b32 v110, v110, v10, vcc
  v_cndmask_b32 v111, v111, v10, vcc
  s_mul_i32 s11, s10, 1216
  s_add_u32 s11, s11, s9
  s_add_u32 s11, s11, 9216
  v_mul_u32_u24 v4, 304, v6
  v_lshl_add_u32 v4, v5, 4, v4
  v_cmp_gt_u32 vcc, 19, v5
  s_and_saveexec_b64 s[12:13], vcc
  buffer_store_dwordx4 v[104:107], v4, s[56:59], s11 offen sc1
  buffer_store_dwordx4 v[108:111], v4, s[56:59], s11 offen offset:608 sc1
  s_lshl_b32 s11, s10, 7
  s_add_u32 s11, s11, s9
  s_add_u32 s11, s11, 8192
  s_mov_b32 exec_lo, -1
  s_mov_b32 exec_hi, 0
  v_lshlrev_b32 v4, 2, v5
  buffer_store_dword v100, v4, s[56:59], s11 offen sc1
  v_cvt_pk_bf16_f32 v120, v26, v26
  v_lshlrev_b32 v120, 16, v120
  v_mul_f32 v120, 0xbfb8aa3b, v120
  v_exp_f32 v120, v120
  s_nop 0
  v_add_f32 v120, 1.0, v120
  v_rcp_f32 v120, v120
  s_nop 0
  v_cvt_pk_bf16_f32 v120, v120, v120
  v_lshlrev_b32 v120, 16, v120
  s_lshl_b32 s11, s5, 7
  s_add_u32 s11, s11, 11534336
  buffer_store_dword v120, v4, s[56:59], s11 offen sc1
  s_endpgm

  K1_END:
  s_endpgm

K1_CONV:
  s_sub_u32 s2, s2, 272
  s_mov_b32 s99, 0

  s_mov_b32 s56, s46
  s_and_b32 s57, s47, 0xffff
  s_mov_b32 s58, 268435456
  s_mov_b32 s59, 0x00020000
  v_lshlrev_b32 v3, 4, v0
  s_lshl_b32 s7, s2, 12
  s_add_u32 s7, s7, 19922944
  buffer_load_dwordx4 v[112:115], v3, s[56:59], s7 offen
  s_mul_i32 s8, s2, 4224
  s_add_u32 s8, s8, 29360128
  buffer_load_dwordx4 v[20:23], v3, s[56:59], s8 offen offset:16
  buffer_load_dwordx4 v[16:19], v3, s[56:59], s8 offen
  s_add_u32 s9, s8, 4096
  buffer_load_dwordx4 v[52:55], v3, s[56:59], s9 offen
  buffer_load_dwordx4 v[48:51], v3, s[56:59], s9 offen offset:16
  v_mov_b32 v28, 0
  v_mov_b32 v29, 0
  v_mov_b32 v30, 0
  v_mov_b32 v31, 0
  v_lshlrev_b32 v6, 4, v0
  v_add_u32 v6, s99, v6
  v_cmp_gt_u32 vcc, 155, v0
  s_and_saveexec_b64 s[12:13], vcc
  ds_write_b128 v6, v[28:31] offset:33280
  s_mov_b64 exec, s[12:13]
  v_lshrrev_b32 v6, 2, v0
  v_mul_u32_u24 v6, 80, v6
  v_and_b32 v7, 3, v0
  v_lshl_add_u32 v6, v7, 4, v6
  v_add_u32 v6, s99, v6
  s_waitcnt vmcnt(4)
  ds_write_b128 v6, v[112:115] offset:35760
  s_waitcnt vmcnt(2)

  v_mov_b32 v10, v0
  v_lshlrev_b32 v13, 4, v10
  v_add_u32 v13, s99, v13
  v_mov_b32 v24, v17
  v_mov_b32 v25, v18
  v_mov_b32 v26, v19
  v_mov_b32 v27, v20
  v_mov_b32 v28, v21
  v_mov_b32 v29, v22
  v_mov_b32 v30, v23
  v_alignbit_b32 v32, v17, v16, 16
  v_alignbit_b32 v33, v18, v17, 16
  v_alignbit_b32 v34, v19, v18, 16
  v_alignbit_b32 v35, v20, v19, 16
  v_alignbit_b32 v36, v21, v20, 16
  v_alignbit_b32 v37, v22, v21, 16
  v_alignbit_b32 v38, v23, v22, 16
  v_alignbit_b32 v40, v18, v17, 16
  v_alignbit_b32 v41, v19, v18, 16
  v_alignbit_b32 v42, v20, v19, 16
  v_alignbit_b32 v43, v21, v20, 16
  v_alignbit_b32 v44, v22, v21, 16
  v_alignbit_b32 v45, v23, v22, 16
  ds_write_b128 v13, v[20:23] offset:0
  ds_write_b128 v13, v[42:45] offset:4160
  ds_write_b128 v13, v[26:29] offset:8320
  ds_write_b128 v13, v[34:37] offset:12480
  ds_write_b128 v13, v[18:21] offset:16640
  ds_write_b128 v13, v[40:43] offset:20800
  ds_write_b128 v13, v[24:27] offset:24960
  ds_write_b128 v13, v[32:35] offset:29120
  v_cmp_gt_u32 vcc, 4, v0
  s_and_saveexec_b64 s[12:13], vcc
  s_cbranch_execz K2_D2_SKIP

  v_add_u32 v10, 256, v0
  v_lshlrev_b32 v13, 4, v10
  v_add_u32 v13, s99, v13
  s_waitcnt vmcnt(0)
  v_mov_b32 v16, v52
  v_mov_b32 v20, v48
  v_mov_b32 v17, v53
  v_mov_b32 v21, v49
  v_mov_b32 v18, v54
  v_mov_b32 v22, v50
  v_mov_b32 v19, v55
  v_mov_b32 v23, v51
  v_mov_b32 v24, v17
  v_mov_b32 v25, v18
  v_mov_b32 v26, v19
  v_mov_b32 v27, v20
  v_mov_b32 v28, v21
  v_mov_b32 v29, v22
  v_mov_b32 v30, v23
  v_alignbit_b32 v32, v17, v16, 16
  v_alignbit_b32 v33, v18, v17, 16
  v_alignbit_b32 v34, v19, v18, 16
  v_alignbit_b32 v35, v20, v19, 16
  v_alignbit_b32 v36, v21, v20, 16
  v_alignbit_b32 v37, v22, v21, 16
  v_alignbit_b32 v38, v23, v22, 16
  v_alignbit_b32 v40, v18, v17, 16
  v_alignbit_b32 v41, v19, v18, 16
  v_alignbit_b32 v42, v20, v19, 16
  v_alignbit_b32 v43, v21, v20, 16
  v_alignbit_b32 v44, v22, v21, 16
  v_alignbit_b32 v45, v23, v22, 16
  ds_write_b128 v13, v[20:23] offset:0
  ds_write_b128 v13, v[42:45] offset:4160
  ds_write_b128 v13, v[26:29] offset:8320
  ds_write_b128 v13, v[34:37] offset:12480
  ds_write_b128 v13, v[18:21] offset:16640
  ds_write_b128 v13, v[40:43] offset:20800
  ds_write_b128 v13, v[24:27] offset:24960
  ds_write_b128 v13, v[32:35] offset:29120
  K2_D2_SKIP:
  s_mov_b64 exec, -1
  s_waitcnt vmcnt(0) lgkmcnt(0)
  s_barrier

  v_and_b32 v4, 31, v2
  v_lshrrev_b32 v5, 5, v2
  v_and_b32 v6, 7, v4
  v_sub_u32 v7, v4, v6
  v_mul_u32_u24 v8, 4160, v6
  v_lshlrev_b32 v9, 4, v5
  v_add_u32 v8, v8, v9
  v_lshlrev_b32 v7, 1, v7
  v_sub_u32 v8, v8, v7
  s_lshl_b32 s8, s3, 5
  s_sub_u32 s8, 144, s8
  v_add_u32 v8, s8, v8
  v_add_u32 v8, s99, v8
  s_lshr_b32 s8, s3, 1
  s_mul_i32 s8, s8, 80
  s_sub_u32 s8, 30800, s8
  s_and_b32 s9, s3, 1
  s_xor_b32 s9, s9, 1
  s_lshl_b32 s9, s9, 5
  s_add_u32 s8, s8, s9
  v_mul_u32_u24 v10, 80, v4
  v_add_u32 v10, v10, v9
  v_add_u32 v10, s8, v10
  v_add_u32 v10, s99, v10

  v_mov_b32 v64, 0
  v_mov_b32 v65, 0
  v_mov_b32 v66, 0
  v_mov_b32 v67, 0
  v_mov_b32 v68, 0
  v_mov_b32 v69, 0
  v_mov_b32 v70, 0
  v_mov_b32 v71, 0
  v_mov_b32 v72, 0
  v_mov_b32 v73, 0
  v_mov_b32 v74, 0
  v_mov_b32 v75, 0
  v_mov_b32 v76, 0
  v_mov_b32 v77, 0
  v_mov_b32 v78, 0
  v_mov_b32 v79, 0
  v_mov_b32 v80, 0
  v_mov_b32 v81, 0
  v_mov_b32 v82, 0
  v_mov_b32 v83, 0
  v_mov_b32 v84, 0
  v_mov_b32 v85, 0
  v_mov_b32 v86, 0
  v_mov_b32 v87, 0
  v_mov_b32 v88, 0
  v_mov_b32 v89, 0
  v_mov_b32 v90, 0
  v_mov_b32 v91, 0
  v_mov_b32 v92, 0
  v_mov_b32 v93, 0
  v_mov_b32 v94, 0
  v_mov_b32 v95, 0
  ds_read_b128 v[16:19], v8 offset:3968
  ds_read_b128 v[20:23], v10 offset:7520
  ds_read_b128 v[24:27], v10 offset:4960
  ds_read_b128 v[28:31], v8 offset:3840
  ds_read_b128 v[32:35], v10 offset:7360
  ds_read_b128 v[36:39], v10 offset:4800
  ds_read_b128 v[40:43], v8 offset:3712
  ds_read_b128 v[44:47], v10 offset:7200
  ds_read_b128 v[48:51], v10 offset:4640
  ds_read_b128 v[52:55], v8 offset:3584
  ds_read_b128 v[56:59], v10 offset:7040
  ds_read_b128 v[60:63], v10 offset:4480
  s_waitcnt lgkmcnt(9)
  v_mfma_f32_32x32x16_bf16 v[80:95], v[16:19], v[20:23], v[80:95]
  v_mfma_f32_32x32x16_bf16 v[64:79], v[16:19], v[24:27], v[64:79]
  ds_read_b128 v[16:19], v8 offset:3456
  ds_read_b128 v[20:23], v10 offset:6880
  ds_read_b128 v[24:27], v10 offset:4320
  s_waitcnt lgkmcnt(9)
  v_mfma_f32_32x32x16_bf16 v[80:95], v[28:31], v[32:35], v[80:95]
  v_mfma_f32_32x32x16_bf16 v[64:79], v[28:31], v[36:39], v[64:79]
  ds_read_b128 v[28:31], v8 offset:3328
  ds_read_b128 v[32:35], v10 offset:6720
  ds_read_b128 v[36:39], v10 offset:4160
  s_waitcnt lgkmcnt(9)
  v_mfma_f32_32x32x16_bf16 v[80:95], v[40:43], v[44:47], v[80:95]
  v_mfma_f32_32x32x16_bf16 v[64:79], v[40:43], v[48:51], v[64:79]
  ds_read_b128 v[40:43], v8 offset:3200
  ds_read_b128 v[44:47], v10 offset:6560
  ds_read_b128 v[48:51], v10 offset:4000
  s_waitcnt lgkmcnt(9)
  v_mfma_f32_32x32x16_bf16 v[80:95], v[52:55], v[56:59], v[80:95]
  v_mfma_f32_32x32x16_bf16 v[64:79], v[52:55], v[60:63], v[64:79]
  ds_read_b128 v[52:55], v8 offset:3072
  ds_read_b128 v[56:59], v10 offset:6400
  ds_read_b128 v[60:63], v10 offset:3840
  s_waitcnt lgkmcnt(9)
  v_mfma_f32_32x32x16_bf16 v[80:95], v[16:19], v[20:23], v[80:95]
  v_mfma_f32_32x32x16_bf16 v[64:79], v[16:19], v[24:27], v[64:79]
  ds_read_b128 v[16:19], v8 offset:2944
  ds_read_b128 v[20:23], v10 offset:6240
  ds_read_b128 v[24:27], v10 offset:3680
  s_waitcnt lgkmcnt(9)
  v_mfma_f32_32x32x16_bf16 v[80:95], v[28:31], v[32:35], v[80:95]
  v_mfma_f32_32x32x16_bf16 v[64:79], v[28:31], v[36:39], v[64:79]
  ds_read_b128 v[28:31], v8 offset:2816
  ds_read_b128 v[32:35], v10 offset:6080
  ds_read_b128 v[36:39], v10 offset:3520
  s_waitcnt lgkmcnt(9)
  v_mfma_f32_32x32x16_bf16 v[80:95], v[40:43], v[44:47], v[80:95]
  v_mfma_f32_32x32x16_bf16 v[64:79], v[40:43], v[48:51], v[64:79]
  ds_read_b128 v[40:43], v8 offset:2688
  ds_read_b128 v[44:47], v10 offset:5920
  ds_read_b128 v[48:51], v10 offset:3360
  s_waitcnt lgkmcnt(9)
  v_mfma_f32_32x32x16_bf16 v[80:95], v[52:55], v[56:59], v[80:95]
  v_mfma_f32_32x32x16_bf16 v[64:79], v[52:55], v[60:63], v[64:79]
  ds_read_b128 v[52:55], v8 offset:2560
  ds_read_b128 v[56:59], v10 offset:5760
  ds_read_b128 v[60:63], v10 offset:3200
  s_waitcnt lgkmcnt(9)
  v_mfma_f32_32x32x16_bf16 v[80:95], v[16:19], v[20:23], v[80:95]
  v_mfma_f32_32x32x16_bf16 v[64:79], v[16:19], v[24:27], v[64:79]
  ds_read_b128 v[16:19], v8 offset:2432
  ds_read_b128 v[20:23], v10 offset:5600
  ds_read_b128 v[24:27], v10 offset:3040
  s_waitcnt lgkmcnt(9)
  v_mfma_f32_32x32x16_bf16 v[80:95], v[28:31], v[32:35], v[80:95]
  v_mfma_f32_32x32x16_bf16 v[64:79], v[28:31], v[36:39], v[64:79]
  ds_read_b128 v[28:31], v8 offset:2304
  ds_read_b128 v[32:35], v10 offset:5440
  ds_read_b128 v[36:39], v10 offset:2880
  s_waitcnt lgkmcnt(9)
  v_mfma_f32_32x32x16_bf16 v[80:95], v[40:43], v[44:47], v[80:95]
  v_mfma_f32_32x32x16_bf16 v[64:79], v[40:43], v[48:51], v[64:79]
  ds_read_b128 v[40:43], v8 offset:2176
  ds_read_b128 v[44:47], v10 offset:5280
  ds_read_b128 v[48:51], v10 offset:2720
  s_waitcnt lgkmcnt(9)
  v_mfma_f32_32x32x16_bf16 v[80:95], v[52:55], v[56:59], v[80:95]
  v_mfma_f32_32x32x16_bf16 v[64:79], v[52:55], v[60:63], v[64:79]
  ds_read_b128 v[52:55], v8 offset:2048
  ds_read_b128 v[56:59], v10 offset:5120
  ds_read_b128 v[60:63], v10 offset:2560
  s_waitcnt lgkmcnt(9)
  v_mfma_f32_32x32x16_bf16 v[80:95], v[16:19], v[20:23], v[80:95]
  v_mfma_f32_32x32x16_bf16 v[64:79], v[16:19], v[24:27], v[64:79]
  ds_read_b128 v[16:19], v8 offset:1920
  ds_read_b128 v[20:23], v10 offset:4960
  s_waitcnt lgkmcnt(8)
  v_mfma_f32_32x32x16_bf16 v[80:95], v[28:31], v[32:35], v[80:95]
  v_mfma_f32_32x32x16_bf16 v[64:79], v[28:31], v[36:39], v[64:79]
  ds_read_b128 v[28:31], v8 offset:1792
  ds_read_b128 v[32:35], v10 offset:4800
  s_waitcnt lgkmcnt(7)
  v_mfma_f32_32x32x16_bf16 v[80:95], v[40:43], v[44:47], v[80:95]
  v_mfma_f32_32x32x16_bf16 v[64:79], v[40:43], v[48:51], v[64:79]
  ds_read_b128 v[40:43], v8 offset:1664
  ds_read_b128 v[44:47], v10 offset:4640
  s_waitcnt lgkmcnt(6)
  v_mfma_f32_32x32x16_bf16 v[80:95], v[52:55], v[56:59], v[80:95]
  v_mfma_f32_32x32x16_bf16 v[64:79], v[52:55], v[60:63], v[64:79]
  ds_read_b128 v[52:55], v8 offset:1536
  ds_read_b128 v[56:59], v10 offset:4480
  s_waitcnt lgkmcnt(6)
  v_mfma_f32_32x32x16_bf16 v[80:95], v[16:19], v[20:23], v[80:95]
  ds_read_b128 v[16:19], v8 offset:1408
  ds_read_b128 v[20:23], v10 offset:4320
  s_waitcnt lgkmcnt(6)
  v_mfma_f32_32x32x16_bf16 v[80:95], v[28:31], v[32:35], v[80:95]
  ds_read_b128 v[28:31], v8 offset:1280
  ds_read_b128 v[32:35], v10 offset:4160
  s_waitcnt lgkmcnt(6)
  v_mfma_f32_32x32x16_bf16 v[80:95], v[40:43], v[44:47], v[80:95]
  ds_read_b128 v[40:43], v8 offset:1152
  ds_read_b128 v[44:47], v10 offset:4000
  s_waitcnt lgkmcnt(6)
  v_mfma_f32_32x32x16_bf16 v[80:95], v[52:55], v[56:59], v[80:95]
  ds_read_b128 v[52:55], v8 offset:1024
  ds_read_b128 v[56:59], v10 offset:3840
  s_waitcnt lgkmcnt(6)
  v_mfma_f32_32x32x16_bf16 v[80:95], v[16:19], v[20:23], v[80:95]
  ds_read_b128 v[16:19], v8 offset:896
  ds_read_b128 v[20:23], v10 offset:3680
  s_waitcnt lgkmcnt(6)
  v_mfma_f32_32x32x16_bf16 v[80:95], v[28:31], v[32:35], v[80:95]
  ds_read_b128 v[28:31], v8 offset:768
  ds_read_b128 v[32:35], v10 offset:3520
  s_waitcnt lgkmcnt(6)
  v_mfma_f32_32x32x16_bf16 v[80:95], v[40:43], v[44:47], v[80:95]
  ds_read_b128 v[40:43], v8 offset:640
  ds_read_b128 v[44:47], v10 offset:3360
  s_waitcnt lgkmcnt(6)
  v_mfma_f32_32x32x16_bf16 v[80:95], v[52:55], v[56:59], v[80:95]
  ds_read_b128 v[52:55], v8 offset:512
  ds_read_b128 v[56:59], v10 offset:3200
  s_waitcnt lgkmcnt(6)
  v_mfma_f32_32x32x16_bf16 v[80:95], v[16:19], v[20:23], v[80:95]
  ds_read_b128 v[16:19], v8 offset:384
  ds_read_b128 v[20:23], v10 offset:3040
  s_waitcnt lgkmcnt(6)
  v_mfma_f32_32x32x16_bf16 v[80:95], v[28:31], v[32:35], v[80:95]
  ds_read_b128 v[28:31], v8 offset:256
  ds_read_b128 v[32:35], v10 offset:2880
  s_waitcnt lgkmcnt(6)
  v_mfma_f32_32x32x16_bf16 v[80:95], v[40:43], v[44:47], v[80:95]
  ds_read_b128 v[40:43], v8 offset:128
  ds_read_b128 v[44:47], v10 offset:2720
  s_waitcnt lgkmcnt(6)
  v_mfma_f32_32x32x16_bf16 v[80:95], v[52:55], v[56:59], v[80:95]
  ds_read_b128 v[52:55], v8 offset:0
  ds_read_b128 v[56:59], v10 offset:2560
  s_waitcnt lgkmcnt(6)
  v_mfma_f32_32x32x16_bf16 v[80:95], v[16:19], v[20:23], v[80:95]
  s_waitcnt lgkmcnt(4)
  v_mfma_f32_32x32x16_bf16 v[80:95], v[28:31], v[32:35], v[80:95]
  s_waitcnt lgkmcnt(2)
  v_mfma_f32_32x32x16_bf16 v[80:95], v[40:43], v[44:47], v[80:95]
  s_waitcnt lgkmcnt(0)
  v_mfma_f32_32x32x16_bf16 v[80:95], v[52:55], v[56:59], v[80:95]
  s_nop 15
  s_barrier
  s_mul_i32 s8, s3, 9216
  v_mul_u32_u24 v8, 144, v4
  v_add_u32 v8, s8, v8
  v_add_u32 v8, v8, v9
  v_add_u32 v8, s99, v8

  ds_write_b128 v8, v[64:67] offset:0
  ds_write_b128 v8, v[68:71] offset:32
  ds_write_b128 v8, v[72:75] offset:64
  ds_write_b128 v8, v[76:79] offset:96
  ds_write_b128 v8, v[80:83] offset:4608
  ds_write_b128 v8, v[84:87] offset:4640
  ds_write_b128 v8, v[88:91] offset:4672
  ds_write_b128 v8, v[92:95] offset:4704
  s_waitcnt lgkmcnt(0)
  s_barrier
  v_lshrrev_b32 v8, 2, v0
  v_mul_u32_u24 v8, 144, v8
  v_and_b32 v9, 3, v0
  v_lshl_add_u32 v8, v9, 5, v8
  v_add_u32 v8, s99, v8

  ds_read_b128 v[16:19], v8 offset:0
  ds_read_b128 v[20:23], v8 offset:16
  ds_read_b128 v[24:27], v8 offset:9216
  ds_read_b128 v[28:31], v8 offset:9232
  ds_read_b128 v[32:35], v8 offset:18432
  ds_read_b128 v[36:39], v8 offset:18448
  ds_read_b128 v[40:43], v8 offset:27648
  ds_read_b128 v[44:47], v8 offset:27664
  s_waitcnt lgkmcnt(0)
  v_add_f32 v16, v16, v24
  v_add_f32 v32, v32, v40
  v_add_f32 v17, v17, v25
  v_add_f32 v33, v33, v41
  v_add_f32 v18, v18, v26
  v_add_f32 v34, v34, v42
  v_add_f32 v19, v19, v27
  v_add_f32 v35, v35, v43
  v_add_f32 v20, v20, v28
  v_add_f32 v36, v36, v44
  v_add_f32 v21, v21, v29
  v_add_f32 v37, v37, v45
  v_add_f32 v22, v22, v30
  v_add_f32 v38, v38, v46
  v_add_f32 v23, v23, v31
  v_add_f32 v39, v39, v47
  v_add_f32 v16, v16, v32
  v_add_f32 v17, v17, v33
  v_add_f32 v18, v18, v34
  v_add_f32 v19, v19, v35
  v_add_f32 v20, v20, v36
  v_add_f32 v21, v21, v37
  v_add_f32 v22, v22, v38
  v_add_f32 v23, v23, v39
  v_cvt_pk_bf16_f32 v48, v16, v17
  v_cvt_pk_bf16_f32 v49, v18, v19
  v_cvt_pk_bf16_f32 v50, v20, v21
  v_cvt_pk_bf16_f32 v51, v22, v23
  s_lshl_b32 s8, s2, 12
  s_add_u32 s8, s8, 5242880
  v_lshlrev_b32 v8, 4, v0
  buffer_store_dwordx4 v[48:51], v8, s[56:59], s8 offen sc1
  s_endpgm

.globl k2_kernel
.p2align 8
.type k2_kernel,@function
k2_kernel:
  s_cmp_ge_u32 s2, 256
  s_cbranch_scc1 K2_END
  s_load_dwordx2 s[46:47], s[0:1], 120
  v_and_b32 v2, 63, v0
  v_lshrrev_b32 v1, 6, v0
  s_nop 0
  v_readfirstlane_b32 s3, v1
  s_waitcnt lgkmcnt(0)

  s_mov_b32 s56, s46
  s_and_b32 s57, s47, 0xffff
  s_mov_b32 s58, 268435456
  s_mov_b32 s59, 0x00020000
  s_add_u32 s60, s46, 4194304
  s_addc_u32 s61, s47, 0
  s_and_b32 s61, s61, 0xffff
  s_mov_b32 s62, 155648
  s_mov_b32 s63, 0x00020000
  s_and_b32 s30, s3, 7
  s_lshr_b32 s31, s3, 3
  s_lshr_b32 s4, s2, 3
  s_lshl_b32 s4, s4, 6
  s_and_b32 s5, s2, 7
  s_lshl_b32 s5, s5, 3
  s_add_u32 s4, s4, s5
  s_add_u32 s4, s4, s30
  s_lshl_b32 s5, s4, 11
  v_lshlrev_b32 v3, 4, v2
  buffer_load_dwordx4 v[4:7], v3, s[56:59], s5 offen
  buffer_load_dwordx4 v[8:11], v3, s[56:59], s5 offen offset:1024

  s_add_u32 s6, s3, 0
  s_mul_i32 s7, s6, 3450
  s_lshr_b32 s7, s7, 16
  s_mul_i32 s9, s7, 19
  s_sub_u32 s9, s6, s9
  s_lshr_b32 s10, s7, 1
  s_and_b32 s7, s7, 1
  s_lshl_b32 s7, s7, 2
  s_add_u32 s7, s7, s10
  s_mul_i32 s7, s7, 19456
  s_lshl_b32 s9, s9, 10
  s_add_u32 s7, s7, s9
  s_cmp_lt_u32 s6, 152
  s_cselect_b32 s7, s7, 155648
  s_mov_b32 m0, s7
  s_nop 0
  buffer_load_dwordx4 v3, s[60:63], s7 offen lds

  s_add_u32 s6, s3, 16
  s_mul_i32 s7, s6, 3450
  s_lshr_b32 s7, s7, 16
  s_mul_i32 s9, s7, 19
  s_sub_u32 s9, s6, s9
  s_lshr_b32 s10, s7, 1
  s_and_b32 s7, s7, 1
  s_lshl_b32 s7, s7, 2
  s_add_u32 s7, s7, s10
  s_mul_i32 s7, s7, 19456
  s_lshl_b32 s9, s9, 10
  s_add_u32 s7, s7, s9
  s_cmp_lt_u32 s6, 152
  s_cselect_b32 s7, s7, 155648
  s_mov_b32 m0, s7
  s_nop 0
  buffer_load_dwordx4 v3, s[60:63], s7 offen lds

  s_add_u32 s6, s3, 32
  s_mul_i32 s7, s6, 3450
  s_lshr_b32 s7, s7, 16
  s_mul_i32 s9, s7, 19
  s_sub_u32 s9, s6, s9
  s_lshr_b32 s10, s7, 1
  s_and_b32 s7, s7, 1
  s_lshl_b32 s7, s7, 2
  s_add_u32 s7, s7, s10
  s_mul_i32 s7, s7, 19456
  s_lshl_b32 s9, s9, 10
  s_add_u32 s7, s7, s9
  s_cmp_lt_u32 s6, 152
  s_cselect_b32 s7, s7, 155648
  s_mov_b32 m0, s7
  s_nop 0
  buffer_load_dwordx4 v3, s[60:63], s7 offen lds

  s_add_u32 s6, s3, 48
  s_mul_i32 s7, s6, 3450
  s_lshr_b32 s7, s7, 16
  s_mul_i32 s9, s7, 19
  s_sub_u32 s9, s6, s9
  s_lshr_b32 s10, s7, 1
  s_and_b32 s7, s7, 1
  s_lshl_b32 s7, s7, 2
  s_add_u32 s7, s7, s10
  s_mul_i32 s7, s7, 19456
  s_lshl_b32 s9, s9, 10
  s_add_u32 s7, s7, s9
  s_cmp_lt_u32 s6, 152
  s_cselect_b32 s7, s7, 155648
  s_mov_b32 m0, s7
  s_nop 0
  buffer_load_dwordx4 v3, s[60:63], s7 offen lds

  s_add_u32 s6, s3, 64
  s_mul_i32 s7, s6, 3450
  s_lshr_b32 s7, s7, 16
  s_mul_i32 s9, s7, 19
  s_sub_u32 s9, s6, s9
  s_lshr_b32 s10, s7, 1
  s_and_b32 s7, s7, 1
  s_lshl_b32 s7, s7, 2
  s_add_u32 s7, s7, s10
  s_mul_i32 s7, s7, 19456
  s_lshl_b32 s9, s9, 10
  s_add_u32 s7, s7, s9
  s_cmp_lt_u32 s6, 152
  s_cselect_b32 s7, s7, 155648
  s_mov_b32 m0, s7
  s_nop 0
  buffer_load_dwordx4 v3, s[60:63], s7 offen lds

  s_add_u32 s6, s3, 80
  s_mul_i32 s7, s6, 3450
  s_lshr_b32 s7, s7, 16
  s_mul_i32 s9, s7, 19
  s_sub_u32 s9, s6, s9
  s_lshr_b32 s10, s7, 1
  s_and_b32 s7, s7, 1
  s_lshl_b32 s7, s7, 2
  s_add_u32 s7, s7, s10
  s_mul_i32 s7, s7, 19456
  s_lshl_b32 s9, s9, 10
  s_add_u32 s7, s7, s9
  s_cmp_lt_u32 s6, 152
  s_cselect_b32 s7, s7, 155648
  s_mov_b32 m0, s7
  s_nop 0
  buffer_load_dwordx4 v3, s[60:63], s7 offen lds

  s_add_u32 s6, s3, 96
  s_mul_i32 s7, s6, 3450
  s_lshr_b32 s7, s7, 16
  s_mul_i32 s9, s7, 19
  s_sub_u32 s9, s6, s9
  s_lshr_b32 s10, s7, 1
  s_and_b32 s7, s7, 1
  s_lshl_b32 s7, s7, 2
  s_add_u32 s7, s7, s10
  s_mul_i32 s7, s7, 19456
  s_lshl_b32 s9, s9, 10
  s_add_u32 s7, s7, s9
  s_cmp_lt_u32 s6, 152
  s_cselect_b32 s7, s7, 155648
  s_mov_b32 m0, s7
  s_nop 0
  buffer_load_dwordx4 v3, s[60:63], s7 offen lds

  s_add_u32 s6, s3, 112
  s_mul_i32 s7, s6, 3450
  s_lshr_b32 s7, s7, 16
  s_mul_i32 s9, s7, 19
  s_sub_u32 s9, s6, s9
  s_lshr_b32 s10, s7, 1
  s_and_b32 s7, s7, 1
  s_lshl_b32 s7, s7, 2
  s_add_u32 s7, s7, s10
  s_mul_i32 s7, s7, 19456
  s_lshl_b32 s9, s9, 10
  s_add_u32 s7, s7, s9
  s_cmp_lt_u32 s6, 152
  s_cselect_b32 s7, s7, 155648
  s_mov_b32 m0, s7
  s_nop 0
  buffer_load_dwordx4 v3, s[60:63], s7 offen lds

  s_add_u32 s6, s3, 128
  s_mul_i32 s7, s6, 3450
  s_lshr_b32 s7, s7, 16
  s_mul_i32 s9, s7, 19
  s_sub_u32 s9, s6, s9
  s_lshr_b32 s10, s7, 1
  s_and_b32 s7, s7, 1
  s_lshl_b32 s7, s7, 2
  s_add_u32 s7, s7, s10
  s_mul_i32 s7, s7, 19456
  s_lshl_b32 s9, s9, 10
  s_add_u32 s7, s7, s9
  s_cmp_lt_u32 s6, 152
  s_cselect_b32 s7, s7, 155648
  s_mov_b32 m0, s7
  s_nop 0
  buffer_load_dwordx4 v3, s[60:63], s7 offen lds

  s_add_u32 s6, s3, 144
  s_mul_i32 s7, s6, 3450
  s_lshr_b32 s7, s7, 16
  s_mul_i32 s9, s7, 19
  s_sub_u32 s9, s6, s9
  s_lshr_b32 s10, s7, 1
  s_and_b32 s7, s7, 1
  s_lshl_b32 s7, s7, 2
  s_add_u32 s7, s7, s10
  s_mul_i32 s7, s7, 19456
  s_lshl_b32 s9, s9, 10
  s_add_u32 s7, s7, s9
  s_cmp_lt_u32 s6, 152
  s_cselect_b32 s7, s7, 155648
  s_mov_b32 m0, s7
  s_nop 0
  buffer_load_dwordx4 v3, s[60:63], s7 offen lds

  v_and_b32 v112, 31, v2
  v_lshrrev_b32 v113, 5, v2
  v_lshlrev_b32 v124, 4, v2
  v_lshlrev_b32 v125, 2, v112
  v_add_u32 v125, 8192, v125
  v_min_u32 v114, 18, v112
  v_lshlrev_b32 v114, 4, v114
  v_mul_u32_u24 v126, 304, v113
  v_add_u32 v126, v126, v114
  v_add_u32 v126, 9216, v126
  s_mul_i32 s7, s31, 77824
  v_add_u32 v124, s7, v124
  v_add_u32 v125, s7, v125
  v_add_u32 v126, s7, v126
  v_cmp_gt_u32 s[20:21], 32, v2

  v_mov_b32 v21, 0x00003f80
  v_mov_b32 v22, 0
  v_mov_b32 v23, 0
  v_mov_b32 v25, 0x00003f80
  v_mov_b32 v26, 0
  v_mov_b32 v27, 0
  v_mov_b32 v84, 0
  v_mov_b32 v85, 0
  v_mov_b32 v86, 0
  v_mov_b32 v87, 0
  v_mov_b32 v88, 0
  v_mov_b32 v89, 0
  v_mov_b32 v90, 0
  v_mov_b32 v91, 0
  v_mov_b32 v92, 0
  v_mov_b32 v93, 0
  v_mov_b32 v94, 0
  v_mov_b32 v95, 0
  v_mov_b32 v96, 0
  v_mov_b32 v97, 0
  v_mov_b32 v98, 0
  v_mov_b32 v99, 0
  s_waitcnt vmcnt(7)
  s_barrier

  ds_read_b128 v[12:15], v124 offset:0
  ds_read_b32 v20, v125 offset:0
  s_waitcnt lgkmcnt(0)
  v_mfma_f32_32x32x16_bf16 v[52:67], v[12:15], v[4:7], 0
  v_mfma_f32_32x32x16_bf16 v[52:67], v[20:23], v[8:11], v[52:67]
  s_nop 15
  s_nop 3
  v_max3_f32 v112, v52, v53, v54
  v_max3_f32 v112, v112, v55, v56
  v_max3_f32 v112, v112, v57, v58
  v_max3_f32 v112, v112, v59, v60
  v_max3_f32 v112, v112, v61, v62
  v_max3_f32 v112, v112, v63, v64
  v_max3_f32 v112, v112, v65, v66
  v_max_f32 v112, v112, v67
  v_mov_b32 v113, v112
  s_nop 1
  v_permlane32_swap_b32 v112, v113
  s_nop 1
  v_max_f32 v112, v112, v113
  v_cvt_pk_bf16_f32 v112, v112, v112
  v_lshlrev_b32 v127, 16, v112

  v_xor_b32 v116, 0x80000000, v127
  v_lshrrev_b32 v116, 16, v116
  v_cndmask_b32 v9, 0, v116, s[20:21]
  s_mov_b32 s8, 0
K2_PRIME:
  ds_read_b128 v[12:15], v124 offset:0
  ds_read_b32 v20, v125 offset:0
  ds_read_b128 v[16:19], v124 offset:1024
  ds_read_b32 v24, v125 offset:128
  ds_read_b128 v[28:31], v126 offset:0
  ds_read_b128 v[32:35], v126 offset:608
  s_waitcnt lgkmcnt(4)
  v_mfma_f32_32x32x16_bf16 v[52:67], v[12:15], v[4:7], 0
  v_mfma_f32_32x32x16_bf16 v[52:67], v[20:23], v[8:11], v[52:67]
  s_nop 15
  s_nop 3
.p2align 6
K2_GROUP:
  v_mov_b32 v100, v84
  v_mov_b32 v101, v85
  v_mov_b32 v102, v86
  v_mov_b32 v103, v87
  v_mov_b32 v104, v88
  v_mov_b32 v105, v89
  v_mov_b32 v106, v90
  v_mov_b32 v107, v91
  v_mov_b32 v108, v92
  v_mov_b32 v109, v93
  v_mov_b32 v110, v94
  v_mov_b32 v111, v95
  s_waitcnt lgkmcnt(2)
  v_mfma_f32_32x32x16_bf16 v[68:83], v[16:19], v[4:7], 0
  v_exp_f32 v52, v52
  v_exp_f32 v53, v53
  v_exp_f32 v54, v54
  v_exp_f32 v55, v55
  v_mfma_f32_32x32x16_bf16 v[68:83], v[24:27], v[8:11], v[68:83]
  ds_read_b128 v[12:15], v124 offset:2048
  ds_read_b32 v20, v125 offset:256
  v_exp_f32 v56, v56
  v_exp_f32 v57, v57
  v_exp_f32 v58, v58
  v_exp_f32 v59, v59
  v_cvt_pk_bf16_f32 v44, v52, v53
  v_cvt_pk_bf16_f32 v45, v54, v55
  v_exp_f32 v60, v60
  v_exp_f32 v61, v61
  v_cvt_pk_bf16_f32 v46, v56, v57
  v_cvt_pk_bf16_f32 v47, v58, v59
  v_exp_f32 v62, v62
  v_exp_f32 v63, v63
  s_waitcnt lgkmcnt(2)
  v_mfma_f32_32x32x16_bf16 v[84:99], v[28:31], v[44:47], v[84:99]
  v_exp_f32 v64, v64
  v_exp_f32 v65, v65
  v_exp_f32 v66, v66
  v_exp_f32 v67, v67
  v_cvt_pk_bf16_f32 v48, v60, v61
  v_cvt_pk_bf16_f32 v49, v62, v63
  ds_read_b128 v[36:39], v126 offset:1216
  ds_read_b128 v[40:43], v126 offset:1824
  v_cvt_pk_bf16_f32 v50, v64, v65
  v_cvt_pk_bf16_f32 v51, v66, v67
  s_nop 1
  v_mfma_f32_32x32x16_bf16 v[84:99], v[32:35], v[48:51], v[84:99]
  s_waitcnt lgkmcnt(2)
  v_mfma_f32_32x32x16_bf16 v[52:67], v[12:15], v[4:7], 0
  v_exp_f32 v68, v68
  v_exp_f32 v69, v69
  v_exp_f32 v70, v70
  v_exp_f32 v71, v71
  v_mfma_f32_32x32x16_bf16 v[52:67], v[20:23], v[8:11], v[52:67]
  ds_read_b128 v[16:19], v124 offset:3072
  ds_read_b32 v24, v125 offset:384
  v_exp_f32 v72, v72
  v_exp_f32 v73, v73
  v_exp_f32 v74, v74
  v_exp_f32 v75, v75
  v_cvt_pk_bf16_f32 v44, v68, v69
  v_cvt_pk_bf16_f32 v45, v70, v71
  v_exp_f32 v76, v76
  v_exp_f32 v77, v77
  v_cvt_pk_bf16_f32 v46, v72, v73
  v_cvt_pk_bf16_f32 v47, v74, v75
  v_exp_f32 v78, v78
  v_exp_f32 v79, v79
  s_waitcnt lgkmcnt(2)
  v_mfma_f32_32x32x16_bf16 v[84:99], v[36:39], v[44:47], v[84:99]
  v_exp_f32 v80, v80
  v_exp_f32 v81, v81
  v_exp_f32 v82, v82
  v_exp_f32 v83, v83
  v_cvt_pk_bf16_f32 v48, v76, v77
  v_cvt_pk_bf16_f32 v49, v78, v79
  ds_read_b128 v[28:31], v126 offset:2432
  ds_read_b128 v[32:35], v126 offset:3040
  v_cvt_pk_bf16_f32 v50, v80, v81
  v_cvt_pk_bf16_f32 v51, v82, v83
  s_nop 1
  v_mfma_f32_32x32x16_bf16 v[84:99], v[40:43], v[48:51], v[84:99]
  s_waitcnt lgkmcnt(2)
  v_mfma_f32_32x32x16_bf16 v[68:83], v[16:19], v[4:7], 0
  v_exp_f32 v52, v52
  v_exp_f32 v53, v53
  v_exp_f32 v54, v54
  v_exp_f32 v55, v55
  v_mfma_f32_32x32x16_bf16 v[68:83], v[24:27], v[8:11], v[68:83]
  ds_read_b128 v[12:15], v124 offset:4096
  ds_read_b32 v20, v125 offset:512
  v_exp_f32 v56, v56
  v_exp_f32 v57, v57
  v_exp_f32 v58, v58
  v_exp_f32 v59, v59
  v_cvt_pk_bf16_f32 v44, v52, v53
  v_cvt_pk_bf16_f32 v45, v54, v55
  v_exp_f32 v60, v60
  v_exp_f32 v61, v61
  v_cvt_pk_bf16_f32 v46, v56, v57
  v_cvt_pk_bf16_f32 v47, v58, v59
  v_exp_f32 v62, v62
  v_exp_f32 v63, v63
  s_waitcnt lgkmcnt(2)
  v_mfma_f32_32x32x16_bf16 v[84:99], v[28:31], v[44:47], v[84:99]
  v_exp_f32 v64, v64
  v_exp_f32 v65, v65
  v_exp_f32 v66, v66
  v_exp_f32 v67, v67
  v_cvt_pk_bf16_f32 v48, v60, v61
  v_cvt_pk_bf16_f32 v49, v62, v63
  ds_read_b128 v[36:39], v126 offset:3648
  ds_read_b128 v[40:43], v126 offset:4256
  v_cvt_pk_bf16_f32 v50, v64, v65
  v_cvt_pk_bf16_f32 v51, v66, v67
  s_nop 1
  v_mfma_f32_32x32x16_bf16 v[84:99], v[32:35], v[48:51], v[84:99]
  s_waitcnt lgkmcnt(2)
  v_mfma_f32_32x32x16_bf16 v[52:67], v[12:15], v[4:7], 0
  v_exp_f32 v68, v68
  v_exp_f32 v69, v69
  v_exp_f32 v70, v70
  v_exp_f32 v71, v71
  v_mfma_f32_32x32x16_bf16 v[52:67], v[20:23], v[8:11], v[52:67]
  ds_read_b128 v[16:19], v124 offset:5120
  ds_read_b32 v24, v125 offset:640
  v_exp_f32 v72, v72
  v_exp_f32 v73, v73
  v_exp_f32 v74, v74
  v_exp_f32 v75, v75
  v_cvt_pk_bf16_f32 v44, v68, v69
  v_cvt_pk_bf16_f32 v45, v70, v71
  v_exp_f32 v76, v76
  v_exp_f32 v77, v77
  v_cvt_pk_bf16_f32 v46, v72, v73
  v_cvt_pk_bf16_f32 v47, v74, v75
  v_exp_f32 v78, v78
  v_exp_f32 v79, v79
  s_waitcnt lgkmcnt(2)
  v_mfma_f32_32x32x16_bf16 v[84:99], v[36:39], v[44:47], v[84:99]
  v_exp_f32 v80, v80
  v_exp_f32 v81, v81
  v_exp_f32 v82, v82
  v_exp_f32 v83, v83
  v_cvt_pk_bf16_f32 v48, v76, v77
  v_cvt_pk_bf16_f32 v49, v78, v79
  ds_read_b128 v[28:31], v126 offset:4864
  ds_read_b128 v[32:35], v126 offset:5472
  v_cvt_pk_bf16_f32 v50, v80, v81
  v_cvt_pk_bf16_f32 v51, v82, v83
  s_nop 1
  v_mfma_f32_32x32x16_bf16 v[84:99], v[40:43], v[48:51], v[84:99]
  s_waitcnt lgkmcnt(2)
  v_mfma_f32_32x32x16_bf16 v[68:83], v[16:19], v[4:7], 0
  v_exp_f32 v52, v52
  v_exp_f32 v53, v53
  v_exp_f32 v54, v54
  v_exp_f32 v55, v55
  v_mfma_f32_32x32x16_bf16 v[68:83], v[24:27], v[8:11], v[68:83]
  ds_read_b128 v[12:15], v124 offset:6144
  ds_read_b32 v20, v125 offset:768
  v_exp_f32 v56, v56
  v_exp_f32 v57, v57
  v_exp_f32 v58, v58
  v_exp_f32 v59, v59
  v_cvt_pk_bf16_f32 v44, v52, v53
  v_cvt_pk_bf16_f32 v45, v54, v55
  v_exp_f32 v60, v60
  v_exp_f32 v61, v61
  v_cvt_pk_bf16_f32 v46, v56, v57
  v_cvt_pk_bf16_f32 v47, v58, v59
  v_exp_f32 v62, v62
  v_exp_f32 v63, v63
  s_waitcnt lgkmcnt(2)
  v_mfma_f32_32x32x16_bf16 v[84:99], v[28:31], v[44:47], v[84:99]
  v_exp_f32 v64, v64
  v_exp_f32 v65, v65
  v_exp_f32 v66, v66
  v_exp_f32 v67, v67
  v_cvt_pk_bf16_f32 v48, v60, v61
  v_cvt_pk_bf16_f32 v49, v62, v63
  ds_read_b128 v[36:39], v126 offset:6080
  ds_read_b128 v[40:43], v126 offset:6688
  v_cvt_pk_bf16_f32 v50, v64, v65
  v_cvt_pk_bf16_f32 v51, v66, v67
  s_nop 1
  v_mfma_f32_32x32x16_bf16 v[84:99], v[32:35], v[48:51], v[84:99]
  s_cmp_ge_u32 s8, 3
  s_cbranch_scc1 K2W_1_skip
  s_cmp_eq_u32 s8, 0
  s_cbranch_scc0 K2W_1_0
  s_waitcnt vmcnt(5)
K2W_1_0:
  s_cmp_eq_u32 s8, 1
  s_cbranch_scc0 K2W_1_1
  s_waitcnt vmcnt(2)
K2W_1_1:
  s_cmp_eq_u32 s8, 2
  s_cbranch_scc0 K2W_1_2
  s_waitcnt vmcnt(0)
K2W_1_2:
  s_barrier
K2W_1_skip:
  s_waitcnt lgkmcnt(2)
  v_mfma_f32_32x32x16_bf16 v[52:67], v[12:15], v[4:7], 0
  v_exp_f32 v68, v68
  v_exp_f32 v69, v69
  v_exp_f32 v70, v70
  v_exp_f32 v71, v71
  v_mfma_f32_32x32x16_bf16 v[52:67], v[20:23], v[8:11], v[52:67]
  ds_read_b128 v[16:19], v124 offset:7168
  ds_read_b32 v24, v125 offset:896
  v_exp_f32 v72, v72
  v_exp_f32 v73, v73
  v_exp_f32 v74, v74
  v_exp_f32 v75, v75
  v_cvt_pk_bf16_f32 v44, v68, v69
  v_cvt_pk_bf16_f32 v45, v70, v71
  v_exp_f32 v76, v76
  v_exp_f32 v77, v77
  v_cvt_pk_bf16_f32 v46, v72, v73
  v_cvt_pk_bf16_f32 v47, v74, v75
  v_exp_f32 v78, v78
  v_exp_f32 v79, v79
  s_waitcnt lgkmcnt(2)
  v_mfma_f32_32x32x16_bf16 v[84:99], v[36:39], v[44:47], v[84:99]
  v_exp_f32 v80, v80
  v_exp_f32 v81, v81
  v_exp_f32 v82, v82
  v_exp_f32 v83, v83
  v_cvt_pk_bf16_f32 v48, v76, v77
  v_cvt_pk_bf16_f32 v49, v78, v79
  ds_read_b128 v[28:31], v126 offset:7296
  ds_read_b128 v[32:35], v126 offset:7904
  v_cvt_pk_bf16_f32 v50, v80, v81
  v_cvt_pk_bf16_f32 v51, v82, v83
  s_nop 1
  v_mfma_f32_32x32x16_bf16 v[84:99], v[40:43], v[48:51], v[84:99]
  s_waitcnt lgkmcnt(2)
  v_mfma_f32_32x32x16_bf16 v[68:83], v[16:19], v[4:7], 0
  v_exp_f32 v52, v52
  v_exp_f32 v53, v53
  v_exp_f32 v54, v54
  v_exp_f32 v55, v55
  v_mfma_f32_32x32x16_bf16 v[68:83], v[24:27], v[8:11], v[68:83]
  ds_read_b128 v[12:15], v124 offset:19456
  ds_read_b32 v20, v125 offset:19456
  v_exp_f32 v56, v56
  v_exp_f32 v57, v57
  v_exp_f32 v58, v58
  v_exp_f32 v59, v59
  v_cvt_pk_bf16_f32 v44, v52, v53
  v_cvt_pk_bf16_f32 v45, v54, v55
  v_exp_f32 v60, v60
  v_exp_f32 v61, v61
  v_cvt_pk_bf16_f32 v46, v56, v57
  v_cvt_pk_bf16_f32 v47, v58, v59
  v_exp_f32 v62, v62
  v_exp_f32 v63, v63
  s_waitcnt lgkmcnt(2)
  v_mfma_f32_32x32x16_bf16 v[84:99], v[28:31], v[44:47], v[84:99]
  v_exp_f32 v64, v64
  v_exp_f32 v65, v65
  v_exp_f32 v66, v66
  v_exp_f32 v67, v67
  v_cvt_pk_bf16_f32 v48, v60, v61
  v_cvt_pk_bf16_f32 v49, v62, v63
  ds_read_b128 v[36:39], v126 offset:8512
  ds_read_b128 v[40:43], v126 offset:9120
  v_cvt_pk_bf16_f32 v50, v64, v65
  v_cvt_pk_bf16_f32 v51, v66, v67
  s_nop 1
  v_mfma_f32_32x32x16_bf16 v[84:99], v[32:35], v[48:51], v[84:99]
  s_waitcnt lgkmcnt(2)
  v_mfma_f32_32x32x16_bf16 v[52:67], v[12:15], v[4:7], 0
  v_exp_f32 v68, v68
  v_exp_f32 v69, v69
  v_exp_f32 v70, v70
  v_exp_f32 v71, v71
  v_mfma_f32_32x32x16_bf16 v[52:67], v[20:23], v[8:11], v[52:67]
  ds_read_b128 v[16:19], v124 offset:20480
  ds_read_b32 v24, v125 offset:19584
  v_exp_f32 v72, v72
  v_exp_f32 v73, v73
  v_exp_f32 v74, v74
  v_exp_f32 v75, v75
  v_cvt_pk_bf16_f32 v44, v68, v69
  v_cvt_pk_bf16_f32 v45, v70, v71
  v_exp_f32 v76, v76
  v_exp_f32 v77, v77
  v_cvt_pk_bf16_f32 v46, v72, v73
  v_cvt_pk_bf16_f32 v47, v74, v75
  v_exp_f32 v78, v78
  v_exp_f32 v79, v79
  s_waitcnt lgkmcnt(2)
  v_mfma_f32_32x32x16_bf16 v[84:99], v[36:39], v[44:47], v[84:99]
  v_exp_f32 v80, v80
  v_exp_f32 v81, v81
  v_exp_f32 v82, v82
  v_exp_f32 v83, v83
  v_cvt_pk_bf16_f32 v48, v76, v77
  v_cvt_pk_bf16_f32 v49, v78, v79
  ds_read_b128 v[28:31], v126 offset:19456
  ds_read_b128 v[32:35], v126 offset:20064
  v_cvt_pk_bf16_f32 v50, v80, v81
  v_cvt_pk_bf16_f32 v51, v82, v83
  s_nop 1
  v_mfma_f32_32x32x16_bf16 v[84:99], v[40:43], v[48:51], v[84:99]
  s_nop 15
  v_mov_b32 v112, 1400897536
  v_cmp_nle_f32 vcc, v94, v112
  s_nop 3
  s_and_b64 vcc, vcc, s[20:21]
  s_cbranch_vccnz K2_SLOW
  K2_NEXT:
  v_add_u32 v124, 19456, v124
  v_add_u32 v125, 19456, v125
  v_add_u32 v126, 19456, v126
  s_add_u32 s8, s8, 1
  s_cmp_lt_u32 s8, 4
  s_cbranch_scc1 K2_GROUP

  s_waitcnt lgkmcnt(0)
  s_barrier
  s_mul_i32 s7, s30, 3328
  v_lshlrev_b32 v118, 2, v2
  v_add_u32 v118, s7, v118
  s_cmp_eq_u32 s31, 0
  s_cbranch_scc1 K2_MRG0

  ds_write_b32 v118, v84 offset:0
  ds_write_b32 v118, v85 offset:256
  ds_write_b32 v118, v86 offset:512
  ds_write_b32 v118, v87 offset:768
  ds_write_b32 v118, v88 offset:1024
  ds_write_b32 v118, v89 offset:1280
  ds_write_b32 v118, v90 offset:1536
  ds_write_b32 v118, v91 offset:1792
  ds_write_b32 v118, v92 offset:2048
  ds_write_b32 v118, v93 offset:2304
  ds_write_b32 v118, v94 offset:2560
  ds_write_b32 v118, v95 offset:2816
  ds_write_b32 v118, v127 offset:3072
  s_waitcnt lgkmcnt(0)
  s_barrier
  s_endpgm
  K2_MRG0:
  s_barrier

  ds_read_b32 v100, v118 offset:0
  ds_read_b32 v101, v118 offset:256
  ds_read_b32 v102, v118 offset:512
  ds_read_b32 v103, v118 offset:768
  ds_read_b32 v104, v118 offset:1024
  ds_read_b32 v105, v118 offset:1280
  ds_read_b32 v106, v118 offset:1536
  ds_read_b32 v107, v118 offset:1792
  ds_read_b32 v108, v118 offset:2048
  ds_read_b32 v109, v118 offset:2304
  ds_read_b32 v110, v118 offset:2560
  ds_read_b32 v111, v118 offset:2816
  ds_read_b32 v119, v118 offset:3072
  s_waitcnt lgkmcnt(0)
  v_max_f32 v120, v127, v119
  v_sub_f32 v121, v127, v120
  v_sub_f32 v122, v119, v120
  v_exp_f32 v121, v121
  v_exp_f32 v122, v122
  s_nop 0

  v_mul_f32 v84, v84, v121
  v_fmac_f32 v84, v100, v122
  v_mul_f32 v85, v85, v121
  v_fmac_f32 v85, v101, v122
  v_mul_f32 v86, v86, v121
  v_fmac_f32 v86, v102, v122
  v_mul_f32 v87, v87, v121
  v_fmac_f32 v87, v103, v122
  v_mul_f32 v88, v88, v121
  v_fmac_f32 v88, v104, v122
  v_mul_f32 v89, v89, v121
  v_fmac_f32 v89, v105, v122
  v_mul_f32 v90, v90, v121
  v_fmac_f32 v90, v106, v122
  v_mul_f32 v91, v91, v121
  v_fmac_f32 v91, v107, v122
  v_mul_f32 v92, v92, v121
  v_fmac_f32 v92, v108, v122
  v_mul_f32 v93, v93, v121
  v_fmac_f32 v93, v109, v122
  v_mul_f32 v94, v94, v121
  v_fmac_f32 v94, v110, v122
  v_mul_f32 v95, v95, v121
  v_fmac_f32 v95, v111, v122
  v_mov_b32 v112, v94
  v_mov_b32 v113, v94
  s_nop 1
  v_permlane32_swap_b32 v113, v112
  s_nop 1
  v_rcp_f32 v112, v113
  s_nop 0

  v_mul_f32 v84, v84, v112
  v_mul_f32 v85, v85, v112
  v_mul_f32 v86, v86, v112
  v_mul_f32 v87, v87, v112
  v_mul_f32 v88, v88, v112
  v_mul_f32 v89, v89, v112
  v_mul_f32 v90, v90, v112
  v_mul_f32 v91, v91, v112
  v_mul_f32 v92, v92, v112
  v_mul_f32 v93, v93, v112
  v_mul_f32 v94, v94, v112
  v_mul_f32 v95, v95, v112
  v_cvt_pk_bf16_f32 v44, v84, v85
  v_cvt_pk_bf16_f32 v45, v86, v87
  v_cvt_pk_bf16_f32 v46, v88, v89
  v_cvt_pk_bf16_f32 v47, v90, v91
  v_cvt_pk_bf16_f32 v48, v92, v93
  v_cvt_pk_bf16_f32 v49, v94, v95
  s_lshr_b32 s9, s4, 6
  s_and_b32 s10, s4, 63
  s_mul_i32 s9, s9, 18
  s_mul_i32 s10, s10, 36864
  s_add_u32 s10, s10, 8388608
  v_and_b32 v114, 31, v2
  v_lshlrev_b32 v114, 4, v114
  v_lshrrev_b32 v115, 5, v2
  v_lshlrev_b32 v115, 2, v115
  v_add_u32 v115, s9, v115

  v_add_u32 v116, 0, v115
  v_lshrrev_b32 v117, 3, v116
  v_lshlrev_b32 v117, 9, v117
  v_and_b32 v116, 7, v116
  v_lshl_add_u32 v117, v116, 1, v117
  v_add_u32 v117, v117, v114

  buffer_store_dword v44, v117, s[56:59], s10 offen
  v_add_u32 v116, 2, v115
  v_lshrrev_b32 v117, 3, v116
  v_lshlrev_b32 v117, 9, v117
  v_and_b32 v116, 7, v116
  v_lshl_add_u32 v117, v116, 1, v117
  v_add_u32 v117, v117, v114

  buffer_store_dword v45, v117, s[56:59], s10 offen
  v_add_u32 v116, 8, v115
  v_lshrrev_b32 v117, 3, v116
  v_lshlrev_b32 v117, 9, v117
  v_and_b32 v116, 7, v116
  v_lshl_add_u32 v117, v116, 1, v117
  v_add_u32 v117, v117, v114

  buffer_store_dword v46, v117, s[56:59], s10 offen
  v_add_u32 v116, 10, v115
  v_lshrrev_b32 v117, 3, v116
  v_lshlrev_b32 v117, 9, v117
  v_and_b32 v116, 7, v116
  v_lshl_add_u32 v117, v116, 1, v117
  v_add_u32 v117, v117, v114

  buffer_store_dword v47, v117, s[56:59], s10 offen
  v_add_u32 v116, 16, v115
  v_lshrrev_b32 v117, 3, v116
  v_lshlrev_b32 v117, 9, v117
  v_and_b32 v116, 7, v116
  v_lshl_add_u32 v117, v116, 1, v117
  v_add_u32 v117, v117, v114

  s_mov_b64 exec, s[20:21]
  buffer_store_dword v48, v117, s[56:59], s10 offen
  K2_END:
  s_endpgm

K2_SLOW:
  s_waitcnt lgkmcnt(0)
  v_mov_b32 v84, v100
  v_mov_b32 v85, v101
  v_mov_b32 v86, v102
  v_mov_b32 v87, v103
  v_mov_b32 v88, v104
  v_mov_b32 v89, v105
  v_mov_b32 v90, v106
  v_mov_b32 v91, v107
  v_mov_b32 v92, v108
  v_mov_b32 v93, v109
  v_mov_b32 v94, v110
  v_mov_b32 v95, v111
  v_mov_b32 v96, 0
  v_mov_b32 v97, 0
  v_mov_b32 v98, 0
  v_mov_b32 v99, 0
  ds_read_b128 v[12:15], v124 offset:0
  ds_read_b32 v20, v125 offset:0
  ds_read_b128 v[28:31], v126 offset:0
  ds_read_b128 v[32:35], v126 offset:608
  s_waitcnt lgkmcnt(0)
  v_mfma_f32_32x32x16_bf16 v[52:67], v[12:15], v[4:7], 0
  v_mfma_f32_32x32x16_bf16 v[52:67], v[20:23], v[8:11], v[52:67]
  s_nop 15
  s_nop 3
  v_max3_f32 v112, v52, v53, v54
  v_max3_f32 v112, v112, v55, v56
  v_max3_f32 v112, v112, v57, v58
  v_max3_f32 v112, v112, v59, v60
  v_max3_f32 v112, v112, v61, v62
  v_max3_f32 v112, v112, v63, v64
  v_max3_f32 v112, v112, v65, v66
  v_max_f32 v112, v112, v67
  v_mov_b32 v113, v112
  s_nop 1
  v_permlane32_swap_b32 v112, v113
  s_nop 1
  v_max_f32 v112, v112, v113
  v_max_f32 v112, 0, v112
  v_add_f32 v112, v112, v127
  v_cvt_pk_bf16_f32 v112, v112, v112
  v_lshlrev_b32 v112, 16, v112
  v_sub_f32 v113, v112, v127
  v_mov_b32 v127, v112
  v_sub_f32 v114, 0, v113
  v_exp_f32 v114, v114

  v_xor_b32 v116, 0x80000000, v127
  v_lshrrev_b32 v116, 16, v116
  v_cndmask_b32 v9, 0, v116, s[20:21]
  v_mul_f32 v84, v84, v114
  v_mul_f32 v85, v85, v114
  v_mul_f32 v86, v86, v114
  v_mul_f32 v87, v87, v114
  v_mul_f32 v88, v88, v114
  v_mul_f32 v89, v89, v114
  v_mul_f32 v90, v90, v114
  v_mul_f32 v91, v91, v114
  v_mul_f32 v92, v92, v114
  v_mul_f32 v93, v93, v114
  v_mul_f32 v94, v94, v114
  v_mul_f32 v95, v95, v114
  v_sub_f32 v52, v52, v113
  v_sub_f32 v53, v53, v113
  v_sub_f32 v54, v54, v113
  v_sub_f32 v55, v55, v113
  v_sub_f32 v56, v56, v113
  v_sub_f32 v57, v57, v113
  v_sub_f32 v58, v58, v113
  v_sub_f32 v59, v59, v113
  v_sub_f32 v60, v60, v113
  v_sub_f32 v61, v61, v113
  v_sub_f32 v62, v62, v113
  v_sub_f32 v63, v63, v113
  v_sub_f32 v64, v64, v113
  v_sub_f32 v65, v65, v113
  v_sub_f32 v66, v66, v113
  v_sub_f32 v67, v67, v113
  v_exp_f32 v52, v52
  v_exp_f32 v53, v53
  v_exp_f32 v54, v54
  v_exp_f32 v55, v55
  v_exp_f32 v56, v56
  v_exp_f32 v57, v57
  v_exp_f32 v58, v58
  v_exp_f32 v59, v59
  v_exp_f32 v60, v60
  v_exp_f32 v61, v61
  v_exp_f32 v62, v62
  v_exp_f32 v63, v63
  v_exp_f32 v64, v64
  v_exp_f32 v65, v65
  v_exp_f32 v66, v66
  v_exp_f32 v67, v67
  s_nop 0
  v_cvt_pk_bf16_f32 v44, v52, v53
  v_cvt_pk_bf16_f32 v45, v54, v55
  v_cvt_pk_bf16_f32 v46, v56, v57
  v_cvt_pk_bf16_f32 v47, v58, v59
  v_cvt_pk_bf16_f32 v48, v60, v61
  v_cvt_pk_bf16_f32 v49, v62, v63
  v_cvt_pk_bf16_f32 v50, v64, v65
  v_cvt_pk_bf16_f32 v51, v66, v67
  s_nop 1
  v_mfma_f32_32x32x16_bf16 v[84:99], v[28:31], v[44:47], v[84:99]
  v_mfma_f32_32x32x16_bf16 v[84:99], v[32:35], v[48:51], v[84:99]
  s_nop 15
  s_nop 3
  ds_read_b128 v[12:15], v124 offset:1024
  ds_read_b32 v20, v125 offset:128
  ds_read_b128 v[28:31], v126 offset:1216
  ds_read_b128 v[32:35], v126 offset:1824
  s_waitcnt lgkmcnt(0)
  v_mfma_f32_32x32x16_bf16 v[52:67], v[12:15], v[4:7], 0
  v_mfma_f32_32x32x16_bf16 v[52:67], v[20:23], v[8:11], v[52:67]
  s_nop 15
  s_nop 3
  v_max3_f32 v112, v52, v53, v54
  v_max3_f32 v112, v112, v55, v56
  v_max3_f32 v112, v112, v57, v58
  v_max3_f32 v112, v112, v59, v60
  v_max3_f32 v112, v112, v61, v62
  v_max3_f32 v112, v112, v63, v64
  v_max3_f32 v112, v112, v65, v66
  v_max_f32 v112, v112, v67
  v_mov_b32 v113, v112
  s_nop 1
  v_permlane32_swap_b32 v112, v113
  s_nop 1
  v_max_f32 v112, v112, v113
  v_max_f32 v112, 0, v112
  v_add_f32 v112, v112, v127
  v_cvt_pk_bf16_f32 v112, v112, v112
  v_lshlrev_b32 v112, 16, v112
  v_sub_f32 v113, v112, v127
  v_mov_b32 v127, v112
  v_sub_f32 v114, 0, v113
  v_exp_f32 v114, v114

  v_xor_b32 v116, 0x80000000, v127
  v_lshrrev_b32 v116, 16, v116
  v_cndmask_b32 v9, 0, v116, s[20:21]
  v_mul_f32 v84, v84, v114
  v_mul_f32 v85, v85, v114
  v_mul_f32 v86, v86, v114
  v_mul_f32 v87, v87, v114
  v_mul_f32 v88, v88, v114
  v_mul_f32 v89, v89, v114
  v_mul_f32 v90, v90, v114
  v_mul_f32 v91, v91, v114
  v_mul_f32 v92, v92, v114
  v_mul_f32 v93, v93, v114
  v_mul_f32 v94, v94, v114
  v_mul_f32 v95, v95, v114
  v_sub_f32 v52, v52, v113
  v_sub_f32 v53, v53, v113
  v_sub_f32 v54, v54, v113
  v_sub_f32 v55, v55, v113
  v_sub_f32 v56, v56, v113
  v_sub_f32 v57, v57, v113
  v_sub_f32 v58, v58, v113
  v_sub_f32 v59, v59, v113
  v_sub_f32 v60, v60, v113
  v_sub_f32 v61, v61, v113
  v_sub_f32 v62, v62, v113
  v_sub_f32 v63, v63, v113
  v_sub_f32 v64, v64, v113
  v_sub_f32 v65, v65, v113
  v_sub_f32 v66, v66, v113
  v_sub_f32 v67, v67, v113
  v_exp_f32 v52, v52
  v_exp_f32 v53, v53
  v_exp_f32 v54, v54
  v_exp_f32 v55, v55
  v_exp_f32 v56, v56
  v_exp_f32 v57, v57
  v_exp_f32 v58, v58
  v_exp_f32 v59, v59
  v_exp_f32 v60, v60
  v_exp_f32 v61, v61
  v_exp_f32 v62, v62
  v_exp_f32 v63, v63
  v_exp_f32 v64, v64
  v_exp_f32 v65, v65
  v_exp_f32 v66, v66
  v_exp_f32 v67, v67
  s_nop 0
  v_cvt_pk_bf16_f32 v44, v52, v53
  v_cvt_pk_bf16_f32 v45, v54, v55
  v_cvt_pk_bf16_f32 v46, v56, v57
  v_cvt_pk_bf16_f32 v47, v58, v59
  v_cvt_pk_bf16_f32 v48, v60, v61
  v_cvt_pk_bf16_f32 v49, v62, v63
  v_cvt_pk_bf16_f32 v50, v64, v65
  v_cvt_pk_bf16_f32 v51, v66, v67
  s_nop 1
  v_mfma_f32_32x32x16_bf16 v[84:99], v[28:31], v[44:47], v[84:99]
  v_mfma_f32_32x32x16_bf16 v[84:99], v[32:35], v[48:51], v[84:99]
  s_nop 15
  s_nop 3
  ds_read_b128 v[12:15], v124 offset:2048
  ds_read_b32 v20, v125 offset:256
  ds_read_b128 v[28:31], v126 offset:2432
  ds_read_b128 v[32:35], v126 offset:3040
  s_waitcnt lgkmcnt(0)
  v_mfma_f32_32x32x16_bf16 v[52:67], v[12:15], v[4:7], 0
  v_mfma_f32_32x32x16_bf16 v[52:67], v[20:23], v[8:11], v[52:67]
  s_nop 15
  s_nop 3
  v_max3_f32 v112, v52, v53, v54
  v_max3_f32 v112, v112, v55, v56
  v_max3_f32 v112, v112, v57, v58
  v_max3_f32 v112, v112, v59, v60
  v_max3_f32 v112, v112, v61, v62
  v_max3_f32 v112, v112, v63, v64
  v_max3_f32 v112, v112, v65, v66
  v_max_f32 v112, v112, v67
  v_mov_b32 v113, v112
  s_nop 1
  v_permlane32_swap_b32 v112, v113
  s_nop 1
  v_max_f32 v112, v112, v113
  v_max_f32 v112, 0, v112
  v_add_f32 v112, v112, v127
  v_cvt_pk_bf16_f32 v112, v112, v112
  v_lshlrev_b32 v112, 16, v112
  v_sub_f32 v113, v112, v127
  v_mov_b32 v127, v112
  v_sub_f32 v114, 0, v113
  v_exp_f32 v114, v114

  v_xor_b32 v116, 0x80000000, v127
  v_lshrrev_b32 v116, 16, v116
  v_cndmask_b32 v9, 0, v116, s[20:21]
  v_mul_f32 v84, v84, v114
  v_mul_f32 v85, v85, v114
  v_mul_f32 v86, v86, v114
  v_mul_f32 v87, v87, v114
  v_mul_f32 v88, v88, v114
  v_mul_f32 v89, v89, v114
  v_mul_f32 v90, v90, v114
  v_mul_f32 v91, v91, v114
  v_mul_f32 v92, v92, v114
  v_mul_f32 v93, v93, v114
  v_mul_f32 v94, v94, v114
  v_mul_f32 v95, v95, v114
  v_sub_f32 v52, v52, v113
  v_sub_f32 v53, v53, v113
  v_sub_f32 v54, v54, v113
  v_sub_f32 v55, v55, v113
  v_sub_f32 v56, v56, v113
  v_sub_f32 v57, v57, v113
  v_sub_f32 v58, v58, v113
  v_sub_f32 v59, v59, v113
  v_sub_f32 v60, v60, v113
  v_sub_f32 v61, v61, v113
  v_sub_f32 v62, v62, v113
  v_sub_f32 v63, v63, v113
  v_sub_f32 v64, v64, v113
  v_sub_f32 v65, v65, v113
  v_sub_f32 v66, v66, v113
  v_sub_f32 v67, v67, v113
  v_exp_f32 v52, v52
  v_exp_f32 v53, v53
  v_exp_f32 v54, v54
  v_exp_f32 v55, v55
  v_exp_f32 v56, v56
  v_exp_f32 v57, v57
  v_exp_f32 v58, v58
  v_exp_f32 v59, v59
  v_exp_f32 v60, v60
  v_exp_f32 v61, v61
  v_exp_f32 v62, v62
  v_exp_f32 v63, v63
  v_exp_f32 v64, v64
  v_exp_f32 v65, v65
  v_exp_f32 v66, v66
  v_exp_f32 v67, v67
  s_nop 0
  v_cvt_pk_bf16_f32 v44, v52, v53
  v_cvt_pk_bf16_f32 v45, v54, v55
  v_cvt_pk_bf16_f32 v46, v56, v57
  v_cvt_pk_bf16_f32 v47, v58, v59
  v_cvt_pk_bf16_f32 v48, v60, v61
  v_cvt_pk_bf16_f32 v49, v62, v63
  v_cvt_pk_bf16_f32 v50, v64, v65
  v_cvt_pk_bf16_f32 v51, v66, v67
  s_nop 1
  v_mfma_f32_32x32x16_bf16 v[84:99], v[28:31], v[44:47], v[84:99]
  v_mfma_f32_32x32x16_bf16 v[84:99], v[32:35], v[48:51], v[84:99]
  s_nop 15
  s_nop 3
  ds_read_b128 v[12:15], v124 offset:3072
  ds_read_b32 v20, v125 offset:384
  ds_read_b128 v[28:31], v126 offset:3648
  ds_read_b128 v[32:35], v126 offset:4256
  s_waitcnt lgkmcnt(0)
  v_mfma_f32_32x32x16_bf16 v[52:67], v[12:15], v[4:7], 0
  v_mfma_f32_32x32x16_bf16 v[52:67], v[20:23], v[8:11], v[52:67]
  s_nop 15
  s_nop 3
  v_max3_f32 v112, v52, v53, v54
  v_max3_f32 v112, v112, v55, v56
  v_max3_f32 v112, v112, v57, v58
  v_max3_f32 v112, v112, v59, v60
  v_max3_f32 v112, v112, v61, v62
  v_max3_f32 v112, v112, v63, v64
  v_max3_f32 v112, v112, v65, v66
  v_max_f32 v112, v112, v67
  v_mov_b32 v113, v112
  s_nop 1
  v_permlane32_swap_b32 v112, v113
  s_nop 1
  v_max_f32 v112, v112, v113
  v_max_f32 v112, 0, v112
  v_add_f32 v112, v112, v127
  v_cvt_pk_bf16_f32 v112, v112, v112
  v_lshlrev_b32 v112, 16, v112
  v_sub_f32 v113, v112, v127
  v_mov_b32 v127, v112
  v_sub_f32 v114, 0, v113
  v_exp_f32 v114, v114

  v_xor_b32 v116, 0x80000000, v127
  v_lshrrev_b32 v116, 16, v116
  v_cndmask_b32 v9, 0, v116, s[20:21]
  v_mul_f32 v84, v84, v114
  v_mul_f32 v85, v85, v114
  v_mul_f32 v86, v86, v114
  v_mul_f32 v87, v87, v114
  v_mul_f32 v88, v88, v114
  v_mul_f32 v89, v89, v114
  v_mul_f32 v90, v90, v114
  v_mul_f32 v91, v91, v114
  v_mul_f32 v92, v92, v114
  v_mul_f32 v93, v93, v114
  v_mul_f32 v94, v94, v114
  v_mul_f32 v95, v95, v114
  v_sub_f32 v52, v52, v113
  v_sub_f32 v53, v53, v113
  v_sub_f32 v54, v54, v113
  v_sub_f32 v55, v55, v113
  v_sub_f32 v56, v56, v113
  v_sub_f32 v57, v57, v113
  v_sub_f32 v58, v58, v113
  v_sub_f32 v59, v59, v113
  v_sub_f32 v60, v60, v113
  v_sub_f32 v61, v61, v113
  v_sub_f32 v62, v62, v113
  v_sub_f32 v63, v63, v113
  v_sub_f32 v64, v64, v113
  v_sub_f32 v65, v65, v113
  v_sub_f32 v66, v66, v113
  v_sub_f32 v67, v67, v113
  v_exp_f32 v52, v52
  v_exp_f32 v53, v53
  v_exp_f32 v54, v54
  v_exp_f32 v55, v55
  v_exp_f32 v56, v56
  v_exp_f32 v57, v57
  v_exp_f32 v58, v58
  v_exp_f32 v59, v59
  v_exp_f32 v60, v60
  v_exp_f32 v61, v61
  v_exp_f32 v62, v62
  v_exp_f32 v63, v63
  v_exp_f32 v64, v64
  v_exp_f32 v65, v65
  v_exp_f32 v66, v66
  v_exp_f32 v67, v67
  s_nop 0
  v_cvt_pk_bf16_f32 v44, v52, v53
  v_cvt_pk_bf16_f32 v45, v54, v55
  v_cvt_pk_bf16_f32 v46, v56, v57
  v_cvt_pk_bf16_f32 v47, v58, v59
  v_cvt_pk_bf16_f32 v48, v60, v61
  v_cvt_pk_bf16_f32 v49, v62, v63
  v_cvt_pk_bf16_f32 v50, v64, v65
  v_cvt_pk_bf16_f32 v51, v66, v67
  s_nop 1
  v_mfma_f32_32x32x16_bf16 v[84:99], v[28:31], v[44:47], v[84:99]
  v_mfma_f32_32x32x16_bf16 v[84:99], v[32:35], v[48:51], v[84:99]
  s_nop 15
  s_nop 3
  ds_read_b128 v[12:15], v124 offset:4096
  ds_read_b32 v20, v125 offset:512
  ds_read_b128 v[28:31], v126 offset:4864
  ds_read_b128 v[32:35], v126 offset:5472
  s_waitcnt lgkmcnt(0)
  v_mfma_f32_32x32x16_bf16 v[52:67], v[12:15], v[4:7], 0
  v_mfma_f32_32x32x16_bf16 v[52:67], v[20:23], v[8:11], v[52:67]
  s_nop 15
  s_nop 3
  v_max3_f32 v112, v52, v53, v54
  v_max3_f32 v112, v112, v55, v56
  v_max3_f32 v112, v112, v57, v58
  v_max3_f32 v112, v112, v59, v60
  v_max3_f32 v112, v112, v61, v62
  v_max3_f32 v112, v112, v63, v64
  v_max3_f32 v112, v112, v65, v66
  v_max_f32 v112, v112, v67
  v_mov_b32 v113, v112
  s_nop 1
  v_permlane32_swap_b32 v112, v113
  s_nop 1
  v_max_f32 v112, v112, v113
  v_max_f32 v112, 0, v112
  v_add_f32 v112, v112, v127
  v_cvt_pk_bf16_f32 v112, v112, v112
  v_lshlrev_b32 v112, 16, v112
  v_sub_f32 v113, v112, v127
  v_mov_b32 v127, v112
  v_sub_f32 v114, 0, v113
  v_exp_f32 v114, v114

  v_xor_b32 v116, 0x80000000, v127
  v_lshrrev_b32 v116, 16, v116
  v_cndmask_b32 v9, 0, v116, s[20:21]
  v_mul_f32 v84, v84, v114
  v_mul_f32 v85, v85, v114
  v_mul_f32 v86, v86, v114
  v_mul_f32 v87, v87, v114
  v_mul_f32 v88, v88, v114
  v_mul_f32 v89, v89, v114
  v_mul_f32 v90, v90, v114
  v_mul_f32 v91, v91, v114
  v_mul_f32 v92, v92, v114
  v_mul_f32 v93, v93, v114
  v_mul_f32 v94, v94, v114
  v_mul_f32 v95, v95, v114
  v_sub_f32 v52, v52, v113
  v_sub_f32 v53, v53, v113
  v_sub_f32 v54, v54, v113
  v_sub_f32 v55, v55, v113
  v_sub_f32 v56, v56, v113
  v_sub_f32 v57, v57, v113
  v_sub_f32 v58, v58, v113
  v_sub_f32 v59, v59, v113
  v_sub_f32 v60, v60, v113
  v_sub_f32 v61, v61, v113
  v_sub_f32 v62, v62, v113
  v_sub_f32 v63, v63, v113
  v_sub_f32 v64, v64, v113
  v_sub_f32 v65, v65, v113
  v_sub_f32 v66, v66, v113
  v_sub_f32 v67, v67, v113
  v_exp_f32 v52, v52
  v_exp_f32 v53, v53
  v_exp_f32 v54, v54
  v_exp_f32 v55, v55
  v_exp_f32 v56, v56
  v_exp_f32 v57, v57
  v_exp_f32 v58, v58
  v_exp_f32 v59, v59
  v_exp_f32 v60, v60
  v_exp_f32 v61, v61
  v_exp_f32 v62, v62
  v_exp_f32 v63, v63
  v_exp_f32 v64, v64
  v_exp_f32 v65, v65
  v_exp_f32 v66, v66
  v_exp_f32 v67, v67
  s_nop 0
  v_cvt_pk_bf16_f32 v44, v52, v53
  v_cvt_pk_bf16_f32 v45, v54, v55
  v_cvt_pk_bf16_f32 v46, v56, v57
  v_cvt_pk_bf16_f32 v47, v58, v59
  v_cvt_pk_bf16_f32 v48, v60, v61
  v_cvt_pk_bf16_f32 v49, v62, v63
  v_cvt_pk_bf16_f32 v50, v64, v65
  v_cvt_pk_bf16_f32 v51, v66, v67
  s_nop 1
  v_mfma_f32_32x32x16_bf16 v[84:99], v[28:31], v[44:47], v[84:99]
  v_mfma_f32_32x32x16_bf16 v[84:99], v[32:35], v[48:51], v[84:99]
  s_nop 15
  s_nop 3
  ds_read_b128 v[12:15], v124 offset:5120
  ds_read_b32 v20, v125 offset:640
  ds_read_b128 v[28:31], v126 offset:6080
  ds_read_b128 v[32:35], v126 offset:6688
  s_waitcnt lgkmcnt(0)
  v_mfma_f32_32x32x16_bf16 v[52:67], v[12:15], v[4:7], 0
  v_mfma_f32_32x32x16_bf16 v[52:67], v[20:23], v[8:11], v[52:67]
  s_nop 15
  s_nop 3
  v_max3_f32 v112, v52, v53, v54
  v_max3_f32 v112, v112, v55, v56
  v_max3_f32 v112, v112, v57, v58
  v_max3_f32 v112, v112, v59, v60
  v_max3_f32 v112, v112, v61, v62
  v_max3_f32 v112, v112, v63, v64
  v_max3_f32 v112, v112, v65, v66
  v_max_f32 v112, v112, v67
  v_mov_b32 v113, v112
  s_nop 1
  v_permlane32_swap_b32 v112, v113
  s_nop 1
  v_max_f32 v112, v112, v113
  v_max_f32 v112, 0, v112
  v_add_f32 v112, v112, v127
  v_cvt_pk_bf16_f32 v112, v112, v112
  v_lshlrev_b32 v112, 16, v112
  v_sub_f32 v113, v112, v127
  v_mov_b32 v127, v112
  v_sub_f32 v114, 0, v113
  v_exp_f32 v114, v114

  v_xor_b32 v116, 0x80000000, v127
  v_lshrrev_b32 v116, 16, v116
  v_cndmask_b32 v9, 0, v116, s[20:21]
  v_mul_f32 v84, v84, v114
  v_mul_f32 v85, v85, v114
  v_mul_f32 v86, v86, v114
  v_mul_f32 v87, v87, v114
  v_mul_f32 v88, v88, v114
  v_mul_f32 v89, v89, v114
  v_mul_f32 v90, v90, v114
  v_mul_f32 v91, v91, v114
  v_mul_f32 v92, v92, v114
  v_mul_f32 v93, v93, v114
  v_mul_f32 v94, v94, v114
  v_mul_f32 v95, v95, v114
  v_sub_f32 v52, v52, v113
  v_sub_f32 v53, v53, v113
  v_sub_f32 v54, v54, v113
  v_sub_f32 v55, v55, v113
  v_sub_f32 v56, v56, v113
  v_sub_f32 v57, v57, v113
  v_sub_f32 v58, v58, v113
  v_sub_f32 v59, v59, v113
  v_sub_f32 v60, v60, v113
  v_sub_f32 v61, v61, v113
  v_sub_f32 v62, v62, v113
  v_sub_f32 v63, v63, v113
  v_sub_f32 v64, v64, v113
  v_sub_f32 v65, v65, v113
  v_sub_f32 v66, v66, v113
  v_sub_f32 v67, v67, v113
  v_exp_f32 v52, v52
  v_exp_f32 v53, v53
  v_exp_f32 v54, v54
  v_exp_f32 v55, v55
  v_exp_f32 v56, v56
  v_exp_f32 v57, v57
  v_exp_f32 v58, v58
  v_exp_f32 v59, v59
  v_exp_f32 v60, v60
  v_exp_f32 v61, v61
  v_exp_f32 v62, v62
  v_exp_f32 v63, v63
  v_exp_f32 v64, v64
  v_exp_f32 v65, v65
  v_exp_f32 v66, v66
  v_exp_f32 v67, v67
  s_nop 0
  v_cvt_pk_bf16_f32 v44, v52, v53
  v_cvt_pk_bf16_f32 v45, v54, v55
  v_cvt_pk_bf16_f32 v46, v56, v57
  v_cvt_pk_bf16_f32 v47, v58, v59
  v_cvt_pk_bf16_f32 v48, v60, v61
  v_cvt_pk_bf16_f32 v49, v62, v63
  v_cvt_pk_bf16_f32 v50, v64, v65
  v_cvt_pk_bf16_f32 v51, v66, v67
  s_nop 1
  v_mfma_f32_32x32x16_bf16 v[84:99], v[28:31], v[44:47], v[84:99]
  v_mfma_f32_32x32x16_bf16 v[84:99], v[32:35], v[48:51], v[84:99]
  s_nop 15
  s_nop 3
  ds_read_b128 v[12:15], v124 offset:6144
  ds_read_b32 v20, v125 offset:768
  ds_read_b128 v[28:31], v126 offset:7296
  ds_read_b128 v[32:35], v126 offset:7904
  s_waitcnt lgkmcnt(0)
  v_mfma_f32_32x32x16_bf16 v[52:67], v[12:15], v[4:7], 0
  v_mfma_f32_32x32x16_bf16 v[52:67], v[20:23], v[8:11], v[52:67]
  s_nop 15
  s_nop 3
  v_max3_f32 v112, v52, v53, v54
  v_max3_f32 v112, v112, v55, v56
  v_max3_f32 v112, v112, v57, v58
  v_max3_f32 v112, v112, v59, v60
  v_max3_f32 v112, v112, v61, v62
  v_max3_f32 v112, v112, v63, v64
  v_max3_f32 v112, v112, v65, v66
  v_max_f32 v112, v112, v67
  v_mov_b32 v113, v112
  s_nop 1
  v_permlane32_swap_b32 v112, v113
  s_nop 1
  v_max_f32 v112, v112, v113
  v_max_f32 v112, 0, v112
  v_add_f32 v112, v112, v127
  v_cvt_pk_bf16_f32 v112, v112, v112
  v_lshlrev_b32 v112, 16, v112
  v_sub_f32 v113, v112, v127
  v_mov_b32 v127, v112
  v_sub_f32 v114, 0, v113
  v_exp_f32 v114, v114

  v_xor_b32 v116, 0x80000000, v127
  v_lshrrev_b32 v116, 16, v116
  v_cndmask_b32 v9, 0, v116, s[20:21]
  v_mul_f32 v84, v84, v114
  v_mul_f32 v85, v85, v114
  v_mul_f32 v86, v86, v114
  v_mul_f32 v87, v87, v114
  v_mul_f32 v88, v88, v114
  v_mul_f32 v89, v89, v114
  v_mul_f32 v90, v90, v114
  v_mul_f32 v91, v91, v114
  v_mul_f32 v92, v92, v114
  v_mul_f32 v93, v93, v114
  v_mul_f32 v94, v94, v114
  v_mul_f32 v95, v95, v114
  v_sub_f32 v52, v52, v113
  v_sub_f32 v53, v53, v113
  v_sub_f32 v54, v54, v113
  v_sub_f32 v55, v55, v113
  v_sub_f32 v56, v56, v113
  v_sub_f32 v57, v57, v113
  v_sub_f32 v58, v58, v113
  v_sub_f32 v59, v59, v113
  v_sub_f32 v60, v60, v113
  v_sub_f32 v61, v61, v113
  v_sub_f32 v62, v62, v113
  v_sub_f32 v63, v63, v113
  v_sub_f32 v64, v64, v113
  v_sub_f32 v65, v65, v113
  v_sub_f32 v66, v66, v113
  v_sub_f32 v67, v67, v113
  v_exp_f32 v52, v52
  v_exp_f32 v53, v53
  v_exp_f32 v54, v54
  v_exp_f32 v55, v55
  v_exp_f32 v56, v56
  v_exp_f32 v57, v57
  v_exp_f32 v58, v58
  v_exp_f32 v59, v59
  v_exp_f32 v60, v60
  v_exp_f32 v61, v61
  v_exp_f32 v62, v62
  v_exp_f32 v63, v63
  v_exp_f32 v64, v64
  v_exp_f32 v65, v65
  v_exp_f32 v66, v66
  v_exp_f32 v67, v67
  s_nop 0
  v_cvt_pk_bf16_f32 v44, v52, v53
  v_cvt_pk_bf16_f32 v45, v54, v55
  v_cvt_pk_bf16_f32 v46, v56, v57
  v_cvt_pk_bf16_f32 v47, v58, v59
  v_cvt_pk_bf16_f32 v48, v60, v61
  v_cvt_pk_bf16_f32 v49, v62, v63
  v_cvt_pk_bf16_f32 v50, v64, v65
  v_cvt_pk_bf16_f32 v51, v66, v67
  s_nop 1
  v_mfma_f32_32x32x16_bf16 v[84:99], v[28:31], v[44:47], v[84:99]
  v_mfma_f32_32x32x16_bf16 v[84:99], v[32:35], v[48:51], v[84:99]
  s_nop 15
  s_nop 3
  ds_read_b128 v[12:15], v124 offset:7168
  ds_read_b32 v20, v125 offset:896
  ds_read_b128 v[28:31], v126 offset:8512
  ds_read_b128 v[32:35], v126 offset:9120
  s_waitcnt lgkmcnt(0)
  v_mfma_f32_32x32x16_bf16 v[52:67], v[12:15], v[4:7], 0
  v_mfma_f32_32x32x16_bf16 v[52:67], v[20:23], v[8:11], v[52:67]
  s_nop 15
  s_nop 3
  v_max3_f32 v112, v52, v53, v54
  v_max3_f32 v112, v112, v55, v56
  v_max3_f32 v112, v112, v57, v58
  v_max3_f32 v112, v112, v59, v60
  v_max3_f32 v112, v112, v61, v62
  v_max3_f32 v112, v112, v63, v64
  v_max3_f32 v112, v112, v65, v66
  v_max_f32 v112, v112, v67
  v_mov_b32 v113, v112
  s_nop 1
  v_permlane32_swap_b32 v112, v113
  s_nop 1
  v_max_f32 v112, v112, v113
  v_max_f32 v112, 0, v112
  v_add_f32 v112, v112, v127
  v_cvt_pk_bf16_f32 v112, v112, v112
  v_lshlrev_b32 v112, 16, v112
  v_sub_f32 v113, v112, v127
  v_mov_b32 v127, v112
  v_sub_f32 v114, 0, v113
  v_exp_f32 v114, v114

  v_xor_b32 v116, 0x80000000, v127
  v_lshrrev_b32 v116, 16, v116
  v_cndmask_b32 v9, 0, v116, s[20:21]
  v_mul_f32 v84, v84, v114
  v_mul_f32 v85, v85, v114
  v_mul_f32 v86, v86, v114
  v_mul_f32 v87, v87, v114
  v_mul_f32 v88, v88, v114
  v_mul_f32 v89, v89, v114
  v_mul_f32 v90, v90, v114
  v_mul_f32 v91, v91, v114
  v_mul_f32 v92, v92, v114
  v_mul_f32 v93, v93, v114
  v_mul_f32 v94, v94, v114
  v_mul_f32 v95, v95, v114
  v_sub_f32 v52, v52, v113
  v_sub_f32 v53, v53, v113
  v_sub_f32 v54, v54, v113
  v_sub_f32 v55, v55, v113
  v_sub_f32 v56, v56, v113
  v_sub_f32 v57, v57, v113
  v_sub_f32 v58, v58, v113
  v_sub_f32 v59, v59, v113
  v_sub_f32 v60, v60, v113
  v_sub_f32 v61, v61, v113
  v_sub_f32 v62, v62, v113
  v_sub_f32 v63, v63, v113
  v_sub_f32 v64, v64, v113
  v_sub_f32 v65, v65, v113
  v_sub_f32 v66, v66, v113
  v_sub_f32 v67, v67, v113
  v_exp_f32 v52, v52
  v_exp_f32 v53, v53
  v_exp_f32 v54, v54
  v_exp_f32 v55, v55
  v_exp_f32 v56, v56
  v_exp_f32 v57, v57
  v_exp_f32 v58, v58
  v_exp_f32 v59, v59
  v_exp_f32 v60, v60
  v_exp_f32 v61, v61
  v_exp_f32 v62, v62
  v_exp_f32 v63, v63
  v_exp_f32 v64, v64
  v_exp_f32 v65, v65
  v_exp_f32 v66, v66
  v_exp_f32 v67, v67
  s_nop 0
  v_cvt_pk_bf16_f32 v44, v52, v53
  v_cvt_pk_bf16_f32 v45, v54, v55
  v_cvt_pk_bf16_f32 v46, v56, v57
  v_cvt_pk_bf16_f32 v47, v58, v59
  v_cvt_pk_bf16_f32 v48, v60, v61
  v_cvt_pk_bf16_f32 v49, v62, v63
  v_cvt_pk_bf16_f32 v50, v64, v65
  v_cvt_pk_bf16_f32 v51, v66, v67
  s_nop 1
  v_mfma_f32_32x32x16_bf16 v[84:99], v[28:31], v[44:47], v[84:99]
  v_mfma_f32_32x32x16_bf16 v[84:99], v[32:35], v[48:51], v[84:99]
  s_nop 15
  s_nop 3
  v_add_u32 v124, 19456, v124
  v_add_u32 v125, 19456, v125
  v_add_u32 v126, 19456, v126
  s_add_u32 s8, s8, 1
  s_cmp_lt_u32 s8, 4
  s_cbranch_scc1 K2_PRIME
  v_subrev_u32 v124, 19456, v124
  s_sub_u32 s8, s8, 1
  s_branch K2_NEXT

.globl k3_kernel
.p2align 8
.type k3_kernel,@function
k3_kernel:
  s_cmp_ge_u32 s2, 144
  s_cbranch_scc1 K3_END
  s_load_dwordx2 s[16:17], s[0:1], 0
  s_load_dwordx2 s[28:29], s[0:1], 48
  s_load_dwordx2 s[42:43], s[0:1], 104
  s_load_dwordx2 s[46:47], s[0:1], 120
  v_and_b32 v2, 63, v0
  v_lshrrev_b32 v1, 6, v0
  s_nop 0
  v_readfirstlane_b32 s3, v1
  s_waitcnt lgkmcnt(0)
  s_lshr_b32 s4, s2, 3
  s_cmp_ge_u32 s4, 9
  s_cselect_b32 s5, 1, 0
  s_cselect_b32 s6, 9, 0
  s_sub_u32 s6, s4, s6
  s_and_b32 s7, s2, 7
  s_lshl_b32 s7, s7, 1
  s_add_u32 s5, s5, s7
  s_lshl_b32 s5, s5, 2
  s_add_u32 s5, s5, s3

  s_mov_b32 s56, s46
  s_and_b32 s57, s47, 0xffff
  s_mov_b32 s58, 268435456
  s_mov_b32 s59, 0x00020000
  s_mov_b32 s72, s16
  s_and_b32 s73, s17, 0xffff
  s_mov_b32 s74, 2359296
  s_mov_b32 s75, 0x00020000
  s_mov_b32 s76, s28
  s_and_b32 s77, s29, 0xffff
  s_mov_b32 s78, 1152
  s_mov_b32 s79, 0x00020000
  s_mov_b32 s88, s42
  s_and_b32 s89, s43, 0xffff
  s_mov_b32 s90, 2359296
  s_mov_b32 s91, 0x00020000
  v_and_b32 v5, 31, v2
  v_lshrrev_b32 v6, 5, v2
  v_lshlrev_b32 v7, 4, v2
  s_lshl_b32 s7, s5, 5
  v_add_u32 v8, s7, v5
  s_movk_i32 s8, 1152
  v_mul_lo_u32 v9, v8, s8
  v_lshl_add_u32 v9, v6, 3, v9
  v_lshlrev_b32 v10, 3, v6
  v_lshlrev_b32 v11, 2, v8
  s_lshl_b32 s9, s6, 7
  s_mul_i32 s80, s5, 36864
  s_add_u32 s80, s80, 8388608
  s_lshl_b32 s10, s3, 10
  s_mul_i32 s84, s6, 73728
  s_add_u32 s84, s84, 26214400
  s_add_u32 s84, s84, s10
  s_add_u32 s85, s84, 36864
  s_mov_b32 s13, 11534336
  buffer_load_dword v128, v11, s[56:59], s13 offen
  v_lshrrev_b32 v12, 2, v2
  v_lshlrev_b32 v12, 12, v12
  v_and_b32 v13, 3, v2
  v_lshl_add_u32 v12, v13, 4, v12
  s_lshl_b32 s14, s6, 18
  s_lshl_b32 s11, s5, 6
  s_add_u32 s14, s14, s11
  s_add_u32 s14, s14, 5242880
  s_lshl_b32 s11, s3, 12
  s_add_u32 s11, s11, 49152

  s_add_u32 m0, s11, 0
  s_add_u32 s12, s14, 0
  buffer_load_dwordx4 v12, s[56:59], s12 offen lds
  s_add_u32 m0, s11, 1024
  s_add_u32 s12, s14, 65536
  buffer_load_dwordx4 v12, s[56:59], s12 offen lds
  s_add_u32 m0, s11, 2048
  s_add_u32 s12, s14, 131072
  buffer_load_dwordx4 v12, s[56:59], s12 offen lds
  s_add_u32 m0, s11, 3072
  s_add_u32 s12, s14, 196608
  buffer_load_dwordx4 v12, s[56:59], s12 offen lds
  buffer_load_dwordx2 v[132:133], v9, s[72:75], s9 offen offset:0
  buffer_load_dwordx2 v[148:149], v10, s[76:79], s9 offen offset:0
  buffer_load_dwordx2 v[134:135], v9, s[72:75], s9 offen offset:16
  buffer_load_dwordx2 v[150:151], v10, s[76:79], s9 offen offset:16
  buffer_load_dwordx2 v[136:137], v9, s[72:75], s9 offen offset:32
  buffer_load_dwordx2 v[152:153], v10, s[76:79], s9 offen offset:32
  buffer_load_dwordx2 v[138:139], v9, s[72:75], s9 offen offset:48
  buffer_load_dwordx2 v[154:155], v10, s[76:79], s9 offen offset:48
  buffer_load_dwordx2 v[140:141], v9, s[72:75], s9 offen offset:64
  buffer_load_dwordx2 v[156:157], v10, s[76:79], s9 offen offset:64
  buffer_load_dwordx2 v[142:143], v9, s[72:75], s9 offen offset:80
  buffer_load_dwordx2 v[158:159], v10, s[76:79], s9 offen offset:80
  buffer_load_dwordx2 v[144:145], v9, s[72:75], s9 offen offset:96
  buffer_load_dwordx2 v[160:161], v10, s[76:79], s9 offen offset:96
  buffer_load_dwordx2 v[146:147], v9, s[72:75], s9 offen offset:112
  buffer_load_dwordx2 v[162:163], v10, s[76:79], s9 offen offset:112
  s_add_u32 s86, s10, 0
  v_mov_b32 v15, v7
  s_add_u32 m0, s86, 0
  s_nop 0
  buffer_load_dwordx4 v7, s[56:59], s84 offen lds
  s_add_u32 s84, s84, 4096
  s_add_u32 m0, s86, 4096
  s_nop 0
  buffer_load_dwordx4 v7, s[56:59], s84 offen lds
  s_add_u32 s84, s84, 4096
  s_add_u32 m0, s86, 8192
  s_nop 0
  buffer_load_dwordx4 v7, s[56:59], s84 offen lds
  s_add_u32 s84, s84, 4096
  s_add_u32 m0, s86, 12288
  s_nop 0
  buffer_load_dwordx4 v7, s[56:59], s85 offen lds
  s_add_u32 s85, s85, 4096
  s_add_u32 m0, s86, 16384
  s_nop 0
  buffer_load_dwordx4 v7, s[56:59], s85 offen lds
  s_add_u32 s85, s85, 4096
  s_add_u32 m0, s86, 20480
  s_nop 0
  buffer_load_dwordx4 v7, s[56:59], s85 offen lds
  s_add_u32 s85, s85, 4096
  buffer_load_dwordx4 v[80:83], v7, s[56:59], s80 offen
  s_add_u32 s80, s80, 1024
  buffer_load_dwordx4 v[84:87], v7, s[56:59], s80 offen
  s_add_u32 s80, s80, 1024
  buffer_load_dwordx4 v[88:91], v7, s[56:59], s80 offen
  s_add_u32 s80, s80, 1024
  buffer_load_dwordx4 v[92:95], v7, s[56:59], s80 offen
  s_add_u32 s80, s80, 1024
  buffer_load_dwordx4 v[96:99], v7, s[56:59], s80 offen
  s_add_u32 s80, s80, 1024
  v_mov_b32 v16, 0
  v_mov_b32 v17, 0
  v_mov_b32 v18, 0
  v_mov_b32 v19, 0
  v_mov_b32 v20, 0
  v_mov_b32 v21, 0
  v_mov_b32 v22, 0
  v_mov_b32 v23, 0
  v_mov_b32 v24, 0
  v_mov_b32 v25, 0
  v_mov_b32 v26, 0
  v_mov_b32 v27, 0
  v_mov_b32 v28, 0
  v_mov_b32 v29, 0
  v_mov_b32 v30, 0
  v_mov_b32 v31, 0
  v_mov_b32 v32, 0
  v_mov_b32 v33, 0
  v_mov_b32 v34, 0
  v_mov_b32 v35, 0
  v_mov_b32 v36, 0
  v_mov_b32 v37, 0
  v_mov_b32 v38, 0
  v_mov_b32 v39, 0
  v_mov_b32 v40, 0
  v_mov_b32 v41, 0
  v_mov_b32 v42, 0
  v_mov_b32 v43, 0
  v_mov_b32 v44, 0
  v_mov_b32 v45, 0
  v_mov_b32 v46, 0
  v_mov_b32 v47, 0
  s_xor_b32 s86, s86, 24576
  s_mov_b32 s87, 3
  s_waitcnt vmcnt(5)
  s_barrier
  ds_read_b128 v[104:107], v15 offset:0
  ds_read_b128 v[108:111], v15 offset:12288
K3_L:
  s_add_u32 m0, s86, 0
  s_nop 0
  buffer_load_dwordx4 v7, s[56:59], s84 offen lds
  s_add_u32 s84, s84, 4096
  ds_read_b128 v[112:115], v15 offset:1024
  ds_read_b128 v[116:119], v15 offset:13312
  buffer_load_dwordx4 v[100:103], v7, s[56:59], s80 offen
  s_add_u32 s80, s80, 1024
  s_waitcnt vmcnt(6) lgkmcnt(2)
  v_mfma_f32_32x32x16_bf16 v[16:31], v[104:107], v[80:83], v[16:31]
  v_mfma_f32_32x32x16_bf16 v[32:47], v[108:111], v[80:83], v[32:47]
  s_add_u32 m0, s86, 4096
  s_nop 0
  buffer_load_dwordx4 v7, s[56:59], s84 offen lds
  s_add_u32 s84, s84, 4096
  ds_read_b128 v[104:107], v15 offset:2048
  ds_read_b128 v[108:111], v15 offset:14336
  buffer_load_dwordx4 v[80:83], v7, s[56:59], s80 offen
  s_add_u32 s80, s80, 1024
  s_waitcnt vmcnt(7) lgkmcnt(2)
  v_mfma_f32_32x32x16_bf16 v[16:31], v[112:115], v[84:87], v[16:31]
  v_mfma_f32_32x32x16_bf16 v[32:47], v[116:119], v[84:87], v[32:47]
  s_add_u32 m0, s86, 8192
  s_nop 0
  buffer_load_dwordx4 v7, s[56:59], s84 offen lds
  s_add_u32 s84, s84, 4096
  ds_read_b128 v[112:115], v15 offset:3072
  ds_read_b128 v[116:119], v15 offset:15360
  buffer_load_dwordx4 v[84:87], v7, s[56:59], s80 offen
  s_add_u32 s80, s80, 1024
  s_waitcnt vmcnt(8) lgkmcnt(2)
  v_mfma_f32_32x32x16_bf16 v[16:31], v[104:107], v[88:91], v[16:31]
  v_mfma_f32_32x32x16_bf16 v[32:47], v[108:111], v[88:91], v[32:47]
  s_add_u32 m0, s86, 12288
  s_nop 0
  buffer_load_dwordx4 v7, s[56:59], s85 offen lds
  s_add_u32 s85, s85, 4096
  ds_read_b128 v[104:107], v15 offset:4096
  ds_read_b128 v[108:111], v15 offset:16384
  buffer_load_dwordx4 v[88:91], v7, s[56:59], s80 offen
  s_add_u32 s80, s80, 1024
  s_waitcnt vmcnt(9) lgkmcnt(2)
  v_mfma_f32_32x32x16_bf16 v[16:31], v[112:115], v[92:95], v[16:31]
  v_mfma_f32_32x32x16_bf16 v[32:47], v[116:119], v[92:95], v[32:47]
  s_add_u32 m0, s86, 16384
  s_nop 0
  buffer_load_dwordx4 v7, s[56:59], s85 offen lds
  s_add_u32 s85, s85, 4096
  ds_read_b128 v[112:115], v15 offset:5120
  ds_read_b128 v[116:119], v15 offset:17408
  buffer_load_dwordx4 v[92:95], v7, s[56:59], s80 offen
  s_add_u32 s80, s80, 1024
  s_waitcnt vmcnt(10) lgkmcnt(2)
  v_mfma_f32_32x32x16_bf16 v[16:31], v[104:107], v[96:99], v[16:31]
  v_mfma_f32_32x32x16_bf16 v[32:47], v[108:111], v[96:99], v[32:47]
  s_add_u32 m0, s86, 20480
  s_nop 0
  buffer_load_dwordx4 v7, s[56:59], s85 offen lds
  s_add_u32 s85, s85, 4096
  ds_read_b128 v[104:107], v15 offset:6144
  ds_read_b128 v[108:111], v15 offset:18432
  buffer_load_dwordx4 v[96:99], v7, s[56:59], s80 offen
  s_add_u32 s80, s80, 1024
  s_waitcnt vmcnt(10) lgkmcnt(2)
  v_mfma_f32_32x32x16_bf16 v[16:31], v[112:115], v[100:103], v[16:31]
  v_mfma_f32_32x32x16_bf16 v[32:47], v[116:119], v[100:103], v[32:47]
  ds_read_b128 v[112:115], v15 offset:7168
  ds_read_b128 v[116:119], v15 offset:19456
  buffer_load_dwordx4 v[100:103], v7, s[56:59], s80 offen
  s_add_u32 s80, s80, 1024
  s_waitcnt vmcnt(9) lgkmcnt(2)
  v_mfma_f32_32x32x16_bf16 v[16:31], v[104:107], v[80:83], v[16:31]
  v_mfma_f32_32x32x16_bf16 v[32:47], v[108:111], v[80:83], v[32:47]
  ds_read_b128 v[104:107], v15 offset:8192
  ds_read_b128 v[108:111], v15 offset:20480
  buffer_load_dwordx4 v[80:83], v7, s[56:59], s80 offen
  s_add_u32 s80, s80, 1024
  s_waitcnt vmcnt(8) lgkmcnt(2)
  v_mfma_f32_32x32x16_bf16 v[16:31], v[112:115], v[84:87], v[16:31]
  v_mfma_f32_32x32x16_bf16 v[32:47], v[116:119], v[84:87], v[32:47]
  ds_read_b128 v[112:115], v15 offset:9216
  ds_read_b128 v[116:119], v15 offset:21504
  buffer_load_dwordx4 v[84:87], v7, s[56:59], s80 offen
  s_add_u32 s80, s80, 1024
  s_waitcnt vmcnt(7) lgkmcnt(2)
  v_mfma_f32_32x32x16_bf16 v[16:31], v[104:107], v[88:91], v[16:31]
  v_mfma_f32_32x32x16_bf16 v[32:47], v[108:111], v[88:91], v[32:47]
  ds_read_b128 v[104:107], v15 offset:10240
  ds_read_b128 v[108:111], v15 offset:22528
  buffer_load_dwordx4 v[88:91], v7, s[56:59], s80 offen
  s_add_u32 s80, s80, 1024
  s_waitcnt vmcnt(6) lgkmcnt(2)
  v_mfma_f32_32x32x16_bf16 v[16:31], v[112:115], v[92:95], v[16:31]
  v_mfma_f32_32x32x16_bf16 v[32:47], v[116:119], v[92:95], v[32:47]
  ds_read_b128 v[112:115], v15 offset:11264
  ds_read_b128 v[116:119], v15 offset:23552
  buffer_load_dwordx4 v[92:95], v7, s[56:59], s80 offen
  s_add_u32 s80, s80, 1024
  s_waitcnt vmcnt(5) lgkmcnt(2)
  v_mfma_f32_32x32x16_bf16 v[16:31], v[104:107], v[96:99], v[16:31]
  v_mfma_f32_32x32x16_bf16 v[32:47], v[108:111], v[96:99], v[32:47]
  s_waitcnt vmcnt(6) lgkmcnt(0)
  s_barrier
  v_xor_b32 v15, 24576, v15
  s_xor_b32 s86, s86, 24576
  ds_read_b128 v[104:107], v15 offset:0
  ds_read_b128 v[108:111], v15 offset:12288
  buffer_load_dwordx4 v[96:99], v7, s[56:59], s80 offen
  s_add_u32 s80, s80, 1024
  s_waitcnt vmcnt(5) lgkmcnt(2)
  v_mfma_f32_32x32x16_bf16 v[16:31], v[112:115], v[100:103], v[16:31]
  v_mfma_f32_32x32x16_bf16 v[32:47], v[116:119], v[100:103], v[32:47]
  s_sub_u32 s87, s87, 1
  s_cmp_lg_u32 s87, 0
  s_cbranch_scc1 K3_L
  s_waitcnt vmcnt(0) lgkmcnt(0)
  s_nop 15

  v_lshrrev_b32 v14, 5, v2
  v_lshlrev_b32 v14, 2, v14
  v_bfe_u32 v15, v2, 2, 2
  v_add_u32 v14, v14, v15
  v_lshlrev_b32 v14, 6, v14
  v_bfe_u32 v15, v2, 4, 1
  v_lshl_add_u32 v14, v15, 5, v14
  v_and_b32 v15, 3, v2
  v_lshl_add_u32 v14, v15, 3, v14
  v_add_u32 v14, s11, v14

  ds_read_b64_tr_b16 v[164:165], v14 offset:0
  ds_read_b64_tr_b16 v[166:167], v14 offset:512
  ds_read_b64_tr_b16 v[168:169], v14 offset:1024
  ds_read_b64_tr_b16 v[170:171], v14 offset:1536
  ds_read_b64_tr_b16 v[172:173], v14 offset:2048
  ds_read_b64_tr_b16 v[174:175], v14 offset:2560
  ds_read_b64_tr_b16 v[176:177], v14 offset:3072
  ds_read_b64_tr_b16 v[178:179], v14 offset:3584
  v_sub_f32 v129, 1.0, v128
  s_waitcnt lgkmcnt(0)

  v_lshlrev_b32 v56, 16, v132
  v_and_b32 v57, 0xffff0000, v132
  v_lshlrev_b32 v58, 16, v148
  v_and_b32 v59, 0xffff0000, v148
  v_lshlrev_b32 v60, 16, v164
  v_and_b32 v61, 0xffff0000, v164
  v_fmac_f32 v60, v56, v58
  v_fmac_f32 v61, v57, v59
  v_mul_f32 v16, v129, v16
  v_mul_f32 v17, v129, v17
  v_fmac_f32 v16, v128, v60
  v_fmac_f32 v17, v128, v61
  v_cvt_pk_bf16_f32 v64, v16, v17

  v_lshlrev_b32 v56, 16, v133
  v_and_b32 v57, 0xffff0000, v133
  v_lshlrev_b32 v58, 16, v149
  v_and_b32 v59, 0xffff0000, v149
  v_lshlrev_b32 v60, 16, v165
  v_and_b32 v61, 0xffff0000, v165
  v_fmac_f32 v60, v56, v58
  v_fmac_f32 v61, v57, v59
  v_mul_f32 v18, v129, v18
  v_mul_f32 v19, v129, v19
  v_fmac_f32 v18, v128, v60
  v_fmac_f32 v19, v128, v61
  v_cvt_pk_bf16_f32 v65, v18, v19

  buffer_store_dwordx2 v[64:65], v9, s[88:91], s9 offen offset:0
  v_lshlrev_b32 v56, 16, v134
  v_and_b32 v57, 0xffff0000, v134
  v_lshlrev_b32 v58, 16, v150
  v_and_b32 v59, 0xffff0000, v150
  v_lshlrev_b32 v60, 16, v166
  v_and_b32 v61, 0xffff0000, v166
  v_fmac_f32 v60, v56, v58
  v_fmac_f32 v61, v57, v59
  v_mul_f32 v20, v129, v20
  v_mul_f32 v21, v129, v21
  v_fmac_f32 v20, v128, v60
  v_fmac_f32 v21, v128, v61
  v_cvt_pk_bf16_f32 v66, v20, v21

  v_lshlrev_b32 v56, 16, v135
  v_and_b32 v57, 0xffff0000, v135
  v_lshlrev_b32 v58, 16, v151
  v_and_b32 v59, 0xffff0000, v151
  v_lshlrev_b32 v60, 16, v167
  v_and_b32 v61, 0xffff0000, v167
  v_fmac_f32 v60, v56, v58
  v_fmac_f32 v61, v57, v59
  v_mul_f32 v22, v129, v22
  v_mul_f32 v23, v129, v23
  v_fmac_f32 v22, v128, v60
  v_fmac_f32 v23, v128, v61
  v_cvt_pk_bf16_f32 v67, v22, v23

  buffer_store_dwordx2 v[66:67], v9, s[88:91], s9 offen offset:16
  v_lshlrev_b32 v56, 16, v136
  v_and_b32 v57, 0xffff0000, v136
  v_lshlrev_b32 v58, 16, v152
  v_and_b32 v59, 0xffff0000, v152
  v_lshlrev_b32 v60, 16, v168
  v_and_b32 v61, 0xffff0000, v168
  v_fmac_f32 v60, v56, v58
  v_fmac_f32 v61, v57, v59
  v_mul_f32 v24, v129, v24
  v_mul_f32 v25, v129, v25
  v_fmac_f32 v24, v128, v60
  v_fmac_f32 v25, v128, v61
  v_cvt_pk_bf16_f32 v64, v24, v25

  v_lshlrev_b32 v56, 16, v137
  v_and_b32 v57, 0xffff0000, v137
  v_lshlrev_b32 v58, 16, v153
  v_and_b32 v59, 0xffff0000, v153
  v_lshlrev_b32 v60, 16, v169
  v_and_b32 v61, 0xffff0000, v169
  v_fmac_f32 v60, v56, v58
  v_fmac_f32 v61, v57, v59
  v_mul_f32 v26, v129, v26
  v_mul_f32 v27, v129, v27
  v_fmac_f32 v26, v128, v60
  v_fmac_f32 v27, v128, v61
  v_cvt_pk_bf16_f32 v65, v26, v27

  buffer_store_dwordx2 v[64:65], v9, s[88:91], s9 offen offset:32
  v_lshlrev_b32 v56, 16, v138
  v_and_b32 v57, 0xffff0000, v138
  v_lshlrev_b32 v58, 16, v154
  v_and_b32 v59, 0xffff0000, v154
  v_lshlrev_b32 v60, 16, v170
  v_and_b32 v61, 0xffff0000, v170
  v_fmac_f32 v60, v56, v58
  v_fmac_f32 v61, v57, v59
  v_mul_f32 v28, v129, v28
  v_mul_f32 v29, v129, v29
  v_fmac_f32 v28, v128, v60
  v_fmac_f32 v29, v128, v61
  v_cvt_pk_bf16_f32 v66, v28, v29

  v_lshlrev_b32 v56, 16, v139
  v_and_b32 v57, 0xffff0000, v139
  v_lshlrev_b32 v58, 16, v155
  v_and_b32 v59, 0xffff0000, v155
  v_lshlrev_b32 v60, 16, v171
  v_and_b32 v61, 0xffff0000, v171
  v_fmac_f32 v60, v56, v58
  v_fmac_f32 v61, v57, v59
  v_mul_f32 v30, v129, v30
  v_mul_f32 v31, v129, v31
  v_fmac_f32 v30, v128, v60
  v_fmac_f32 v31, v128, v61
  v_cvt_pk_bf16_f32 v67, v30, v31

  buffer_store_dwordx2 v[66:67], v9, s[88:91], s9 offen offset:48
  v_lshlrev_b32 v56, 16, v140
  v_and_b32 v57, 0xffff0000, v140
  v_lshlrev_b32 v58, 16, v156
  v_and_b32 v59, 0xffff0000, v156
  v_lshlrev_b32 v60, 16, v172
  v_and_b32 v61, 0xffff0000, v172
  v_fmac_f32 v60, v56, v58
  v_fmac_f32 v61, v57, v59
  v_mul_f32 v32, v129, v32
  v_mul_f32 v33, v129, v33
  v_fmac_f32 v32, v128, v60
  v_fmac_f32 v33, v128, v61
  v_cvt_pk_bf16_f32 v64, v32, v33

  v_lshlrev_b32 v56, 16, v141
  v_and_b32 v57, 0xffff0000, v141
  v_lshlrev_b32 v58, 16, v157
  v_and_b32 v59, 0xffff0000, v157
  v_lshlrev_b32 v60, 16, v173
  v_and_b32 v61, 0xffff0000, v173
  v_fmac_f32 v60, v56, v58
  v_fmac_f32 v61, v57, v59
  v_mul_f32 v34, v129, v34
  v_mul_f32 v35, v129, v35
  v_fmac_f32 v34, v128, v60
  v_fmac_f32 v35, v128, v61
  v_cvt_pk_bf16_f32 v65, v34, v35

  buffer_store_dwordx2 v[64:65], v9, s[88:91], s9 offen offset:64
  v_lshlrev_b32 v56, 16, v142
  v_and_b32 v57, 0xffff0000, v142
  v_lshlrev_b32 v58, 16, v158
  v_and_b32 v59, 0xffff0000, v158
  v_lshlrev_b32 v60, 16, v174
  v_and_b32 v61, 0xffff0000, v174
  v_fmac_f32 v60, v56, v58
  v_fmac_f32 v61, v57, v59
  v_mul_f32 v36, v129, v36
  v_mul_f32 v37, v129, v37
  v_fmac_f32 v36, v128, v60
  v_fmac_f32 v37, v128, v61
  v_cvt_pk_bf16_f32 v66, v36, v37

  v_lshlrev_b32 v56, 16, v143
  v_and_b32 v57, 0xffff0000, v143
  v_lshlrev_b32 v58, 16, v159
  v_and_b32 v59, 0xffff0000, v159
  v_lshlrev_b32 v60, 16, v175
  v_and_b32 v61, 0xffff0000, v175
  v_fmac_f32 v60, v56, v58
  v_fmac_f32 v61, v57, v59
  v_mul_f32 v38, v129, v38
  v_mul_f32 v39, v129, v39
  v_fmac_f32 v38, v128, v60
  v_fmac_f32 v39, v128, v61
  v_cvt_pk_bf16_f32 v67, v38, v39

  buffer_store_dwordx2 v[66:67], v9, s[88:91], s9 offen offset:80
  v_lshlrev_b32 v56, 16, v144
  v_and_b32 v57, 0xffff0000, v144
  v_lshlrev_b32 v58, 16, v160
  v_and_b32 v59, 0xffff0000, v160
  v_lshlrev_b32 v60, 16, v176
  v_and_b32 v61, 0xffff0000, v176
  v_fmac_f32 v60, v56, v58
  v_fmac_f32 v61, v57, v59
  v_mul_f32 v40, v129, v40
  v_mul_f32 v41, v129, v41
  v_fmac_f32 v40, v128, v60
  v_fmac_f32 v41, v128, v61
  v_cvt_pk_bf16_f32 v64, v40, v41

  v_lshlrev_b32 v56, 16, v145
  v_and_b32 v57, 0xffff0000, v145
  v_lshlrev_b32 v58, 16, v161
  v_and_b32 v59, 0xffff0000, v161
  v_lshlrev_b32 v60, 16, v177
  v_and_b32 v61, 0xffff0000, v177
  v_fmac_f32 v60, v56, v58
  v_fmac_f32 v61, v57, v59
  v_mul_f32 v42, v129, v42
  v_mul_f32 v43, v129, v43
  v_fmac_f32 v42, v128, v60
  v_fmac_f32 v43, v128, v61
  v_cvt_pk_bf16_f32 v65, v42, v43

  buffer_store_dwordx2 v[64:65], v9, s[88:91], s9 offen offset:96
  v_lshlrev_b32 v56, 16, v146
  v_and_b32 v57, 0xffff0000, v146
  v_lshlrev_b32 v58, 16, v162
  v_and_b32 v59, 0xffff0000, v162
  v_lshlrev_b32 v60, 16, v178
  v_and_b32 v61, 0xffff0000, v178
  v_fmac_f32 v60, v56, v58
  v_fmac_f32 v61, v57, v59
  v_mul_f32 v44, v129, v44
  v_mul_f32 v45, v129, v45
  v_fmac_f32 v44, v128, v60
  v_fmac_f32 v45, v128, v61
  v_cvt_pk_bf16_f32 v66, v44, v45

  v_lshlrev_b32 v56, 16, v147
  v_and_b32 v57, 0xffff0000, v147
  v_lshlrev_b32 v58, 16, v163
  v_and_b32 v59, 0xffff0000, v163
  v_lshlrev_b32 v60, 16, v179
  v_and_b32 v61, 0xffff0000, v179
  v_fmac_f32 v60, v56, v58
  v_fmac_f32 v61, v57, v59
  v_mul_f32 v46, v129, v46
  v_mul_f32 v47, v129, v47
  v_fmac_f32 v46, v128, v60
  v_fmac_f32 v47, v128, v61
  v_cvt_pk_bf16_f32 v67, v46, v47

  buffer_store_dwordx2 v[66:67], v9, s[88:91], s9 offen offset:112
  K3_END:
  s_endpgm

.section .rodata,"a"
.p2align 6
.amdhsa_kernel k0_kernel
  .amdhsa_next_free_vgpr 128
  .amdhsa_next_free_sgpr 102
  .amdhsa_accum_offset 128
  .amdhsa_group_segment_fixed_size 0
  .amdhsa_kernarg_size 128
  .amdhsa_user_sgpr_count 2
  .amdhsa_user_sgpr_kernarg_segment_ptr 1
  .amdhsa_system_sgpr_workgroup_id_x 1
.end_amdhsa_kernel
.p2align 6
.amdhsa_kernel k1_kernel
  .amdhsa_next_free_vgpr 128
  .amdhsa_next_free_sgpr 102
  .amdhsa_accum_offset 128
  .amdhsa_group_segment_fixed_size 0
  .amdhsa_kernarg_size 128
  .amdhsa_user_sgpr_count 2
  .amdhsa_user_sgpr_kernarg_segment_ptr 1
  .amdhsa_system_sgpr_workgroup_id_x 1
.end_amdhsa_kernel
.p2align 6
.amdhsa_kernel k2_kernel
  .amdhsa_next_free_vgpr 128
  .amdhsa_next_free_sgpr 102
  .amdhsa_accum_offset 128
  .amdhsa_group_segment_fixed_size 0
  .amdhsa_kernarg_size 128
  .amdhsa_user_sgpr_count 2
  .amdhsa_user_sgpr_kernarg_segment_ptr 1
  .amdhsa_system_sgpr_workgroup_id_x 1
.end_amdhsa_kernel
.p2align 6
.amdhsa_kernel k3_kernel
  .amdhsa_next_free_vgpr 180
  .amdhsa_next_free_sgpr 102
  .amdhsa_accum_offset 180
  .amdhsa_group_segment_fixed_size 0
  .amdhsa_kernarg_size 128
  .amdhsa_user_sgpr_count 2
  .amdhsa_user_sgpr_kernarg_segment_ptr 1
  .amdhsa_system_sgpr_workgroup_id_x 1
.end_amdhsa_kernel
```
